```python
import torch

def _softmax(x, axis=-1):
    return torch.softmax(x, dim=axis)
def _gelu(x):
    return torch.nn.functional.gelu(x, approximate="tanh")
def _silu(x):
    return torch.nn.functional.silu(x)
def _sigmoid(x):
    return torch.sigmoid(x)
def _layernorm(x, axis=-1, eps=1e-5):
    m = x.mean(dim=axis, keepdim=True)
    v = x.var(dim=axis, keepdim=True, unbiased=False)
    return (x - m) / torch.sqrt(v + eps)
def _scatter_add(tgt, idx, src, axis=0):
    return tgt.clone().index_add_(axis, idx, src)
def _segment_sum(src, seg, n):
    out = torch.zeros((n,) + src.shape[1:], dtype=src.dtype)
    return out.index_add_(0, seg, src)
def _pad(x, pw):
    flat = tuple(v for pair in reversed(pw) for v in pair)
    return torch.nn.functional.pad(x, flat)

kernel_name = 'interleave_layers__ssm_conv_s4d__glu_gated_glu__prompt'

def setup_inputs():

    _w = (lambda a: (lambda t: t.to(torch.bfloat16) if t.is_floating_point() else t)(torch.as_tensor(a)))
    def _A_setup():
        Bsz, L, D, N = 1, 2048, 512, 128
        return {
            "u": _w((lambda *s: torch.randn(*s, dtype=torch.bfloat16) * 0.05)(Bsz, L, D)),
            "log_A_real": _w((lambda *s: torch.randn(*s, dtype=torch.bfloat16) * 3.2)(D, N) * 0.5),
            "A_imag": _w((lambda *s: torch.randn(*s, dtype=torch.bfloat16) * 0.1)(D, N) * 3.14),
            "C_real": _w((lambda *s: torch.randn(*s, dtype=torch.bfloat16) * 0.1)(D, N) / N ** 0.5),
            "C_imag": _w((lambda *s: torch.randn(*s, dtype=torch.bfloat16) * 0.1)(D, N) / N ** 0.5),
            "log_dt": _w((lambda *s: torch.randn(*s, dtype=torch.bfloat16) * 0.1)(D) * 0.5 - 4.0),
            "D_skip": _w((lambda *s: torch.randn(*s, dtype=torch.bfloat16) * 0.1)(D)),
        }
    _A_in = _A_setup()

    def _B_setup():
        B, S, D, F = 1, 2048, 512, 1376
        return {
            "x": _w((lambda *s: torch.randn(*s, dtype=torch.bfloat16) * 0.05)(B, S, D)),
            "w_gate": _w((lambda *s: torch.randn(*s, dtype=torch.bfloat16) * 0.05)(D, F)),
            "w_up": _w((lambda *s: torch.randn(*s, dtype=torch.bfloat16) * 0.05)(D, F)),
            "w_down": _w((lambda *s: torch.randn(*s, dtype=torch.bfloat16) * 0.05)(F, D)),
        }
    _B_in = _B_setup()

    return {
        "A_u": _A_in["u"],
        "A_log_A_real": _A_in["log_A_real"],
        "A_A_imag": _A_in["A_imag"],
        "A_C_real": _A_in["C_real"],
        "A_C_imag": _A_in["C_imag"],
        "A_log_dt": _A_in["log_dt"],
        "A_D_skip": _A_in["D_skip"],
        "B_x": _B_in["x"],
        "B_w_gate": _B_in["w_gate"],
        "B_w_up": _B_in["w_up"],
        "B_w_down": _B_in["w_down"],
    }

def reference(A_u, A_log_A_real, A_A_imag, A_C_real, A_C_imag, A_log_dt, A_D_skip, B_x, B_w_gate, B_w_up, B_w_down):
    def _A_ref(u, log_A_real, A_imag, C_real, C_imag, log_dt, D_skip):
        L = u.shape[1]
        dt = torch.exp(log_dt)
        A = -torch.exp(log_A_real) + 1j * A_imag
        C = (C_real + 1j * C_imag) * dt[:, None]
        pos = (lambda x, dt: x.to(dt))(torch.arange(L), log_dt.dtype)
        P = torch.exp((A * dt[:, None])[:, :, None] * pos[None, None, :])
        K = 2.0 * torch.einsum("dn,dnl->dl", C, P).real
        L2 = 2 * L
        u_t = (lambda x, *d: x.permute(*d))(u, 0, 2, 1)
        Kf = (lambda x, *a, **k: torch.fft.rfft(x.float(), *a, **k))(K, L2)
        Uf = (lambda x, *a, **k: torch.fft.rfft(x.float(), *a, **k))(u_t, L2)
        y = (lambda x, *a, **k: torch.fft.irfft(x, *a, **k).to(torch.bfloat16))(Uf * Kf[None, :, :], L2)[:, :, :L]
        y = (lambda x, *d: x.permute(*d))(y, 0, 2, 1)
        return y + u * D_skip[None, None, :]

    def _B_ref(x, w_gate, w_up, w_down):
        g = torch.einsum("bsd,df->bsf", x, w_gate)
        u = torch.einsum("bsd,df->bsf", x, w_up)
        h = _sigmoid(g) * u
        return torch.einsum("bsf,fd->bsd", h, w_down)

    x = A_u
    x = x + _A_ref(_layernorm(x, axis=-1), A_log_A_real, A_A_imag, A_C_real, A_C_imag, A_log_dt, A_D_skip)
    x = x + _B_ref(_layernorm(x, axis=-1), B_w_gate, B_w_up, B_w_down)
    x = x + _A_ref(_layernorm(x, axis=-1), A_log_A_real, A_A_imag, A_C_real, A_C_imag, A_log_dt, A_D_skip)
    x = x + _B_ref(_layernorm(x, axis=-1), B_w_gate, B_w_up, B_w_down)
    return x
```

```asm
; @launch grid=(256,1,1) block=(512,1,1) lds=132352
.amdgcn_target "amdgcn-amd-amdhsa--gfx950"
.text
.globl interleave_layers__ssm_conv_s4d__glu_gated_glu__prompt_kernel
.p2align 8
.type interleave_layers__ssm_conv_s4d__glu_gated_glu__prompt_kernel,@function
interleave_layers__ssm_conv_s4d__glu_gated_glu__prompt_kernel:
    s_cmp_ge_u32 s2, 256
    s_cbranch_scc1 L_mega_end
    s_load_dwordx8 s[36:43], s[0:1], 8
    s_load_dwordx4 s[12:15], s[0:1], 40
    s_load_dwordx8 s[20:27], s[0:1], 64
    s_load_dwordx4 s[16:19], s[0:1], 96
    s_load_dwordx2 s[28:29], s[0:1], 0
    v_and_b32 v1, 63, v0
    v_lshrrev_b32 v2, 6, v0
    s_mov_b32 s10, 31457280
    v_readfirstlane_b32 s3, v2
    s_mov_b32 s11, 0x00020000
    s_lshr_b32 s4, s3, 2
    s_and_b32 s45, s3, 3
    s_lshl_b32 s44, s2, 1
    s_add_u32 s44, s44, s4
    s_mul_i32 s34, s4, 20480
    s_add_u32 s34, s34, 42432
    v_and_b32 v3, 31, v1
    s_lshl_b32 s4, s44, 7
    s_lshl_b32 s5, s45, 5
    s_add_u32 s4, s4, s5
    v_add_u32 v4, s4, v3
    v_lshlrev_b32 v4, 1, v4
    s_lshl_b32 s5, s44, 1
    v_mov_b32 v5, s5
    v_mov_b32 v158, 131136
    v_mov_b32 v159, 0
    ds_write_b32 v158, v159 offset:4
    ds_write_b32 v158, v159 offset:8
    s_waitcnt lgkmcnt(0)
    s_barrier
    s_mov_b32 s8, s18
    s_mov_b32 s9, s19
    s_mov_b64 s[46:47], s[12:13]
    s_mov_b64 s[98:99], s[16:17]
    s_mov_b64 s[16:17], s[14:15]
    s_mov_b64 s[96:97], s[26:27]
    s_mov_b64 s[26:27], s[24:25]
    s_mov_b64 s[24:25], s[28:29]
    s_lshl_b32 s54, s2, 3
    s_add_u32 s54, s54, s3
    v_mov_b32 v152, 0
    v_mov_b32 v155, 1
    s_mov_b32 s55, 8544256
    s_cmp_lg_u32 s54, 7
    s_cbranch_scc1 L_nn
    buffer_load_dword v154, v152, s[8:11], s55 offen sc1
    L_nn:
    global_load_ushort v6, v4, s[36:37]
    global_load_ushort v10, v5, s[46:47]
    global_load_ushort v7, v4, s[38:39]
    global_load_ushort v8, v4, s[40:41]
    global_load_ushort v9, v4, s[42:43]
    v_lshlrev_b32 v116, 4, v1
    v_lshrrev_b32 v117, 4, v1
    v_and_b32 v118, 15, v1
    v_lshrrev_b32 v120, 2, v1
    v_and_b32 v121, 3, v1
    s_mov_b32 s51, 0x00020000
    s_mov_b32 s59, 0x00020000
    s_lshl_b32 s52, s2, 2
    s_add_u32 s52, s52, s45
    s_lshl_b32 s53, s45, 13
    s_add_u32 s53, s53, 98304
    s_cmp_lt_u32 s3, 4
    s_cbranch_scc1 L_si_w
    s_mov_b32 s48, s24
    s_mov_b32 s49, s25
    s_mov_b32 s50, 2097152
    s_lshl_b32 s4, s52, 11
    buffer_load_dwordx4 v[112:115], v116, s[48:51], s4 offen
    buffer_load_dwordx4 v[160:163], v116, s[48:51], s4 offen offset:1024
    v_lshlrev_b32 v120, 10, v120
    v_lshl_add_u32 v120, v121, 4, v120
    s_lshr_b32 s4, s2, 2
    s_lshl_b32 s4, s4, 15
    s_and_b32 s5, s52, 15
    s_lshl_b32 s5, s5, 6
    s_add_u32 s4, s4, s5
    s_lshl_b32 s53, s45, 11
    s_add_u32 s53, s53, 90112
    s_mov_b32 m0, s53
    s_add_u32 s5, s4, 16384
    buffer_load_dwordx4 v120, s[48:51], s4 offen lds
    s_add_u32 m0, s53, 1024
    s_mov_b32 s58, 0
    buffer_load_dwordx4 v120, s[48:51], s5 offen lds
    s_mov_b32 s56, s24
    s_mov_b32 s57, s25
    buffer_load_dword v164, v116, s[56:59], 0 offen
    buffer_load_dword v164, v116, s[56:59], 0 offen
    buffer_load_dword v164, v116, s[56:59], 0 offen
    buffer_load_dword v164, v116, s[56:59], 0 offen
    s_branch L_si_done
    L_si_w:
    s_mov_b32 s50, 1409024
    s_mov_b32 s58, 1409024
    s_cmp_ge_u32 s52, 860
    s_cselect_b32 s50, 0, s50
    s_cmp_ge_u32 s52, 688
    s_cbranch_scc1 L_si_wd
    s_mov_b32 s48, s20
    s_mov_b32 s49, s21
    s_mov_b32 s56, s22
    s_mov_b32 s57, s23
    v_mul_u32_u24 v120, 2752, v120
    v_lshl_add_u32 v120, v121, 4, v120
    s_and_b32 s4, s52, 15
    s_mul_i32 s4, s4, 88064
    s_lshr_b32 s5, s52, 4
    s_lshl_b32 s5, s5, 6
    s_add_u32 s4, s4, s5
    s_add_u32 m0, s53, 0
    s_nop 0
    buffer_load_dwordx4 v120, s[48:51], s4 offen lds
    s_add_u32 m0, s53, 1024
    s_nop 0
    buffer_load_dwordx4 v120, s[56:59], s4 offen lds
    s_add_u32 s4, s4, 44032
    s_add_u32 m0, s53, 2048
    s_nop 0
    buffer_load_dwordx4 v120, s[48:51], s4 offen lds
    s_add_u32 m0, s53, 3072
    s_nop 0
    buffer_load_dwordx4 v120, s[56:59], s4 offen lds
    s_add_u32 s4, s4, 44032
    s_mov_b32 s58, 0
    buffer_load_dword v164, v116, s[56:59], 0 offen
    buffer_load_dword v164, v116, s[56:59], 0 offen
    buffer_load_dword v164, v116, s[56:59], 0 offen
    buffer_load_dword v164, v116, s[56:59], 0 offen
    s_branch L_si_done
    L_si_wd:
    s_mov_b32 s48, s26
    s_mov_b32 s49, s27
    v_lshrrev_b32 v120, 5, v1
    v_and_b32 v121, 31, v1
    v_lshlrev_b32 v120, 10, v120
    v_lshl_add_u32 v120, v121, 4, v120
    s_sub_u32 s4, s52, 688
    s_and_b32 s5, s4, 1
    s_lshr_b32 s4, s4, 1
    s_lshl_b32 s4, s4, 14
    s_lshl_b32 s5, s5, 9
    s_add_u32 s4, s4, s5
    s_add_u32 m0, s53, 0
    s_nop 0
    buffer_load_dwordx4 v120, s[48:51], s4 offen lds
    s_add_u32 s4, s4, 2048
    s_add_u32 m0, s53, 1024
    s_nop 0
    buffer_load_dwordx4 v120, s[48:51], s4 offen lds
    s_add_u32 s4, s4, 2048
    s_add_u32 m0, s53, 2048
    s_nop 0
    buffer_load_dwordx4 v120, s[48:51], s4 offen lds
    s_add_u32 s4, s4, 2048
    s_add_u32 m0, s53, 3072
    s_nop 0
    buffer_load_dwordx4 v120, s[48:51], s4 offen lds
    s_add_u32 s4, s4, 2048
    s_add_u32 m0, s53, 4096
    s_nop 0
    buffer_load_dwordx4 v120, s[48:51], s4 offen lds
    s_add_u32 s4, s4, 2048
    s_add_u32 m0, s53, 5120
    s_nop 0
    buffer_load_dwordx4 v120, s[48:51], s4 offen lds
    s_add_u32 s4, s4, 2048
    s_add_u32 m0, s53, 6144
    s_nop 0
    buffer_load_dwordx4 v120, s[48:51], s4 offen lds
    s_add_u32 s4, s4, 2048
    s_add_u32 m0, s53, 7168
    s_nop 0
    buffer_load_dwordx4 v120, s[48:51], s4 offen lds
    s_add_u32 s4, s4, 2048
L_si_done:
    s_mov_b32 s30, 0x3fb8aa3b
    s_mov_b32 s31, 0x32a57060
    s_mov_b32 s32, 0x3f317218
    s_mov_b32 s33, 0x3e22f983
    v_and_b32 v0, 255, v0
    v_and_b32 v11, 15, v1
    v_lshrrev_b32 v12, 3, v11
    v_lshlrev_b32 v12, 7, v12
    v_and_b32 v13, 7, v11
    v_add_u32 v12, v12, v13
    v_cvt_f32_u32 v20, v12
    v_lshrrev_b32 v12, 2, v11
    v_lshlrev_b32 v12, 7, v12
    v_and_b32 v13, 3, v11
    v_lshl_add_u32 v12, v13, 1, v12
    v_add_u32 v12, 0x100, v12
    v_subrev_u32 v13, 8, v11
    v_lshrrev_b32 v13, 1, v13
    v_lshlrev_b32 v13, 7, v13
    v_and_b32 v14, 1, v11
    v_lshl_add_u32 v13, v14, 2, v13
    v_add_u32 v13, 0x200, v13
    v_cmp_gt_u32 vcc, 8, v11
    v_lshlrev_b32 v14, 7, v11
    v_add_u32 v14, 0x400, v14
    v_cndmask_b32 v12, v13, v12, vcc
    v_cvt_f32_u32 v21, v12
    v_cvt_f32_u32 v22, v14
    v_lshlrev_b32 v14, 3, v11
    v_cvt_f32_u32 v23, v14
    s_lshl_b32 s5, s45, 9
    s_add_u32 s5, s5, s34
    v_lshl_add_u32 v2, v3, 4, s5
    v_lshrrev_b32 v3, 4, v1
    v_lshl_add_u32 v3, v3, 6, s5
    v_mov_b32 v24, 0
    v_mov_b32 v25, 0
    v_mov_b32 v26, 0
    v_mov_b32 v27, 0
    v_mov_b32 v28, 0
    v_mov_b32 v29, 0
    v_mov_b32 v30, 0
    v_mov_b32 v31, 0
    v_mov_b32 v32, 0
    v_mov_b32 v33, 0
    v_mov_b32 v34, 0
    v_mov_b32 v35, 0
    s_waitcnt vmcnt(11)
    v_lshlrev_b32 v6, 16, v6
    v_lshlrev_b32 v10, 16, v10
    v_mul_f32 v12, s30, v6
    v_mul_f32 v14, s30, v10
    v_fma_f32 v13, v6, s30, -v12
    v_fma_f32 v15, v10, s30, -v14
    v_fmac_f32 v13, s31, v6
    v_fmac_f32 v15, s31, v10
    v_exp_f32 v12, v12
    v_exp_f32 v14, v14
    v_mul_f32 v13, s32, v13
    v_mul_f32 v15, s32, v15
    v_fma_f32 v12, v12, v13, v12
    v_fma_f32 v14, v14, v15, v14
    v_cvt_pk_bf16_f32 v12, v12, v14
    v_lshlrev_b32 v6, 16, v12
    v_and_b32 v10, 0xffff0000, v12
    s_waitcnt vmcnt(8)
    v_lshlrev_b32 v7, 16, v7
    v_lshlrev_b32 v8, 16, v8
    v_lshlrev_b32 v9, 16, v9
    v_mul_f32 v6, v6, v10
    v_mul_f32 v7, v7, v10
    v_add_f32 v10, v10, v10
    v_mul_f32 v18, v8, v10
    v_mul_f32 v19, v9, v10
    v_mul_f32 v16, s30, v6
    v_max_f32 v12, |v18|, |v19|
    v_mul_f32 v17, s33, v7
    v_sub_f32 v16, 0, v16
    v_max_f32_dpp v12, v12, v12 row_ror:8 row_mask:0xf bank_mask:0xf
    s_nop 1
    v_max_f32_dpp v12, v12, v12 row_ror:4 row_mask:0xf bank_mask:0xf
    s_nop 1
    v_max_f32_dpp v12, v12, v12 row_ror:2 row_mask:0xf bank_mask:0xf
    s_nop 1
    v_max_f32_dpp v12, v12, v12 row_ror:1 row_mask:0xf bank_mask:0xf
    s_nop 1
    v_readlane_b32 s6, v12, 0
    v_readlane_b32 s7, v12, 16
    s_max_u32 s6, s6, s7
    s_lshr_b32 s6, s6, 23
    s_max_u32 s6, s6, 1
    s_min_u32 s6, s6, 252
    s_sub_u32 s7, 253, s6
    s_lshl_b32 s7, s7, 23
    s_add_u32 s35, s6, 1
    s_lshl_b32 s35, s35, 23
    v_mul_f32 v18, s7, v18
    v_mul_f32 v19, s7, v19
    ds_write_b128 v2, v[16:19]
    s_waitcnt lgkmcnt(0)
    ds_read_b128 v[36:39], v3 offset:0
    ds_read_b128 v[40:43], v3 offset:16
    ds_read_b128 v[44:47], v3 offset:32
    ds_read_b128 v[48:51], v3 offset:48
    ds_read_b128 v[52:55], v3 offset:256
    ds_read_b128 v[56:59], v3 offset:272
    ds_read_b128 v[60:63], v3 offset:288
    ds_read_b128 v[64:67], v3 offset:304
    s_cmp_lg_u32 s54, 7
    s_cbranch_scc1 L_nn2
    v_add_u32 v154, 1, v154
    v_max_u32 v154, 1, v154
    s_mov_b64 exec, 1
    buffer_store_dword v154, v152, s[8:11], s55 offen sc1
    s_mov_b64 exec, -1
    L_nn2:
    s_waitcnt lgkmcnt(7)
    v_mul_f32 v68, v36, v20
    v_mul_f32 v69, v36, v21
    v_mul_f32 v70, v36, v22
    v_mul_f32 v71, v36, v23
    v_mul_f32 v72, v37, v20
    v_mul_f32 v73, v37, v21
    v_mul_f32 v74, v37, v22
    v_mul_f32 v75, v37, v23
    v_exp_f32 v68, v68
    v_exp_f32 v69, v69
    v_exp_f32 v70, v70
    v_exp_f32 v71, v71
    v_fract_f32 v72, v72
    v_fract_f32 v73, v73
    v_fract_f32 v74, v74
    v_fract_f32 v75, v75
    v_cos_f32 v76, v72
    v_cos_f32 v77, v73
    v_cos_f32 v78, v74
    v_cos_f32 v79, v75
    v_sin_f32 v4, v72
    v_sin_f32 v5, v73
    v_sin_f32 v6, v74
    v_sin_f32 v7, v75
    v_mul_f32 v8, v71, v38
    v_mul_f32 v9, v71, v39
    v_fma_mixlo_f16 v80, v68, v76, 0
    v_fma_mixlo_f16 v84, v69, v77, 0
    v_fma_mixlo_f16 v88, v70, v78, 0
    v_mul_f32 v10, v8, v79
    v_mul_f32 v11, v8, v7
    v_fma_mixhi_f16 v80, v68, v4, 0
    v_fma_mixhi_f16 v84, v69, v5, 0
    v_fma_mixhi_f16 v88, v70, v6, 0
    v_fma_mixlo_f16 v92, -v9, v7, v10
    s_nop 0
    v_fma_mixhi_f16 v92, -v9, v79, -v11
    s_waitcnt lgkmcnt(6)
    v_mul_f32 v68, v40, v20
    v_mul_f32 v69, v40, v21
    v_mul_f32 v70, v40, v22
    v_mul_f32 v71, v40, v23
    v_mul_f32 v72, v41, v20
    v_mul_f32 v73, v41, v21
    v_mul_f32 v74, v41, v22
    v_mul_f32 v75, v41, v23
    v_exp_f32 v68, v68
    v_exp_f32 v69, v69
    v_exp_f32 v70, v70
    v_exp_f32 v71, v71
    v_fract_f32 v72, v72
    v_fract_f32 v73, v73
    v_fract_f32 v74, v74
    v_fract_f32 v75, v75
    v_cos_f32 v76, v72
    v_cos_f32 v77, v73
    v_cos_f32 v78, v74
    v_cos_f32 v79, v75
    v_sin_f32 v4, v72
    v_sin_f32 v5, v73
    v_sin_f32 v6, v74
    v_sin_f32 v7, v75
    v_mul_f32 v8, v71, v42
    v_mul_f32 v9, v71, v43
    v_fma_mixlo_f16 v81, v68, v76, 0
    v_fma_mixlo_f16 v85, v69, v77, 0
    v_fma_mixlo_f16 v89, v70, v78, 0
    v_mul_f32 v10, v8, v79
    v_mul_f32 v11, v8, v7
    v_fma_mixhi_f16 v81, v68, v4, 0
    v_fma_mixhi_f16 v85, v69, v5, 0
    v_fma_mixhi_f16 v89, v70, v6, 0
    v_fma_mixlo_f16 v93, -v9, v7, v10
    s_nop 0
    v_fma_mixhi_f16 v93, -v9, v79, -v11
    s_waitcnt lgkmcnt(5)
    v_mul_f32 v68, v44, v20
    v_mul_f32 v69, v44, v21
    v_mul_f32 v70, v44, v22
    v_mul_f32 v71, v44, v23
    v_mul_f32 v72, v45, v20
    v_mul_f32 v73, v45, v21
    v_mul_f32 v74, v45, v22
    v_mul_f32 v75, v45, v23
    v_exp_f32 v68, v68
    v_exp_f32 v69, v69
    v_exp_f32 v70, v70
    v_exp_f32 v71, v71
    v_fract_f32 v72, v72
    v_fract_f32 v73, v73
    v_fract_f32 v74, v74
    v_fract_f32 v75, v75
    v_cos_f32 v76, v72
    v_cos_f32 v77, v73
    v_cos_f32 v78, v74
    v_cos_f32 v79, v75
    v_sin_f32 v4, v72
    v_sin_f32 v5, v73
    v_sin_f32 v6, v74
    v_sin_f32 v7, v75
    v_mul_f32 v8, v71, v46
    v_mul_f32 v9, v71, v47
    v_fma_mixlo_f16 v82, v68, v76, 0
    v_fma_mixlo_f16 v86, v69, v77, 0
    v_fma_mixlo_f16 v90, v70, v78, 0
    v_mul_f32 v10, v8, v79
    v_mul_f32 v11, v8, v7
    v_fma_mixhi_f16 v82, v68, v4, 0
    v_fma_mixhi_f16 v86, v69, v5, 0
    v_fma_mixhi_f16 v90, v70, v6, 0
    v_fma_mixlo_f16 v94, -v9, v7, v10
    s_nop 0
    v_fma_mixhi_f16 v94, -v9, v79, -v11
    s_waitcnt lgkmcnt(4)
    v_mul_f32 v68, v48, v20
    v_mul_f32 v69, v48, v21
    v_mul_f32 v70, v48, v22
    v_mul_f32 v71, v48, v23
    v_mul_f32 v72, v49, v20
    v_mul_f32 v73, v49, v21
    v_mul_f32 v74, v49, v22
    v_mul_f32 v75, v49, v23
    v_exp_f32 v68, v68
    v_exp_f32 v69, v69
    v_exp_f32 v70, v70
    v_exp_f32 v71, v71
    v_fract_f32 v72, v72
    v_fract_f32 v73, v73
    v_fract_f32 v74, v74
    v_fract_f32 v75, v75
    v_cos_f32 v76, v72
    v_cos_f32 v77, v73
    v_cos_f32 v78, v74
    v_cos_f32 v79, v75
    v_sin_f32 v4, v72
    v_sin_f32 v5, v73
    v_sin_f32 v6, v74
    v_sin_f32 v7, v75
    v_mul_f32 v8, v71, v50
    v_mul_f32 v9, v71, v51
    v_fma_mixlo_f16 v83, v68, v76, 0
    v_fma_mixlo_f16 v87, v69, v77, 0
    v_fma_mixlo_f16 v91, v70, v78, 0
    v_mul_f32 v10, v8, v79
    v_mul_f32 v11, v8, v7
    v_fma_mixhi_f16 v83, v68, v4, 0
    v_fma_mixhi_f16 v87, v69, v5, 0
    v_fma_mixhi_f16 v91, v70, v6, 0
    v_fma_mixlo_f16 v95, -v9, v7, v10
    s_nop 0
    v_fma_mixhi_f16 v95, -v9, v79, -v11
    s_waitcnt lgkmcnt(3)
    v_mul_f32 v68, v52, v20
    v_mul_f32 v69, v52, v21
    v_mul_f32 v70, v52, v22
    v_mul_f32 v71, v52, v23
    v_mul_f32 v72, v53, v20
    v_mul_f32 v73, v53, v21
    v_mul_f32 v74, v53, v22
    v_mul_f32 v75, v53, v23
    v_exp_f32 v68, v68
    v_exp_f32 v69, v69
    v_exp_f32 v70, v70
    v_exp_f32 v71, v71
    v_fract_f32 v72, v72
    v_fract_f32 v73, v73
    v_fract_f32 v74, v74
    v_fract_f32 v75, v75
    v_cos_f32 v76, v72
    v_cos_f32 v77, v73
    v_cos_f32 v78, v74
    v_cos_f32 v79, v75
    v_sin_f32 v4, v72
    v_sin_f32 v5, v73
    v_sin_f32 v6, v74
    v_sin_f32 v7, v75
    v_mul_f32 v8, v71, v54
    v_mul_f32 v9, v71, v55
    v_fma_mixlo_f16 v96, v68, v76, 0
    v_fma_mixlo_f16 v100, v69, v77, 0
    v_fma_mixlo_f16 v104, v70, v78, 0
    v_mul_f32 v10, v8, v79
    v_mul_f32 v11, v8, v7
    v_fma_mixhi_f16 v96, v68, v4, 0
    v_fma_mixhi_f16 v100, v69, v5, 0
    v_fma_mixhi_f16 v104, v70, v6, 0
    v_fma_mixlo_f16 v108, -v9, v7, v10
    v_mfma_f32_16x16x32_f16 v[24:27], v[80:83], v[92:95], v[24:27]
    v_mfma_f32_16x16x32_f16 v[28:31], v[84:87], v[92:95], v[28:31]
    v_mfma_f32_16x16x32_f16 v[32:35], v[88:91], v[92:95], v[32:35]
    v_fma_mixhi_f16 v108, -v9, v79, -v11
    s_waitcnt lgkmcnt(2)
    v_mul_f32 v68, v56, v20
    v_mul_f32 v69, v56, v21
    v_mul_f32 v70, v56, v22
    v_mul_f32 v71, v56, v23
    v_mul_f32 v72, v57, v20
    v_mul_f32 v73, v57, v21
    v_mul_f32 v74, v57, v22
    v_mul_f32 v75, v57, v23
    v_exp_f32 v68, v68
    v_exp_f32 v69, v69
    v_exp_f32 v70, v70
    v_exp_f32 v71, v71
    v_fract_f32 v72, v72
    v_fract_f32 v73, v73
    v_fract_f32 v74, v74
    v_fract_f32 v75, v75
    v_cos_f32 v76, v72
    v_cos_f32 v77, v73
    v_cos_f32 v78, v74
    v_cos_f32 v79, v75
    v_sin_f32 v4, v72
    v_sin_f32 v5, v73
    v_sin_f32 v6, v74
    v_sin_f32 v7, v75
    v_mul_f32 v8, v71, v58
    v_mul_f32 v9, v71, v59
    v_fma_mixlo_f16 v97, v68, v76, 0
    v_fma_mixlo_f16 v101, v69, v77, 0
    v_fma_mixlo_f16 v105, v70, v78, 0
    v_mul_f32 v10, v8, v79
    v_mul_f32 v11, v8, v7
    v_fma_mixhi_f16 v97, v68, v4, 0
    v_fma_mixhi_f16 v101, v69, v5, 0
    v_fma_mixhi_f16 v105, v70, v6, 0
    v_fma_mixlo_f16 v109, -v9, v7, v10
    s_nop 0
    v_fma_mixhi_f16 v109, -v9, v79, -v11
    s_waitcnt lgkmcnt(1)
    v_mul_f32 v68, v60, v20
    v_mul_f32 v69, v60, v21
    v_mul_f32 v70, v60, v22
    v_mul_f32 v71, v60, v23
    v_mul_f32 v72, v61, v20
    v_mul_f32 v73, v61, v21
    v_mul_f32 v74, v61, v22
    v_mul_f32 v75, v61, v23
    v_exp_f32 v68, v68
    v_exp_f32 v69, v69
    v_exp_f32 v70, v70
    v_exp_f32 v71, v71
    v_fract_f32 v72, v72
    v_fract_f32 v73, v73
    v_fract_f32 v74, v74
    v_fract_f32 v75, v75
    v_cos_f32 v76, v72
    v_cos_f32 v77, v73
    v_cos_f32 v78, v74
    v_cos_f32 v79, v75
    v_sin_f32 v4, v72
    v_sin_f32 v5, v73
    v_sin_f32 v6, v74
    v_sin_f32 v7, v75
    v_mul_f32 v8, v71, v62
    v_mul_f32 v9, v71, v63
    v_fma_mixlo_f16 v98, v68, v76, 0
    v_fma_mixlo_f16 v102, v69, v77, 0
    v_fma_mixlo_f16 v106, v70, v78, 0
    v_mul_f32 v10, v8, v79
    v_mul_f32 v11, v8, v7
    v_fma_mixhi_f16 v98, v68, v4, 0
    v_fma_mixhi_f16 v102, v69, v5, 0
    v_fma_mixhi_f16 v106, v70, v6, 0
    v_fma_mixlo_f16 v110, -v9, v7, v10
    s_nop 0
    v_fma_mixhi_f16 v110, -v9, v79, -v11
    v_lshrrev_b32 v122, 5, v1
    v_lshrrev_b32 v120, 2, v118
    v_and_b32 v121, 3, v118
    v_and_b32 v123, 16, v1
    s_cmp_lt_u32 s3, 4
    s_cbranch_scc1 L_sp_w
    v_mov_b32 v124, 0
    v_mov_b32 v125, 0
    v_mov_b32 v126, 0
    v_mov_b32 v127, 0
    v_mov_b32 v136, 0x3f803f80
    v_lshl_add_u32 v120, v117, 3, v120
    v_lshlrev_b32 v120, 6, v120
    v_lshl_add_u32 v120, v121, 3, v120
    v_add_u32 v120, s53, v120
    s_waitcnt vmcnt(0)
    s_cmp_lg_u32 s54, 7
    s_cbranch_scc1 L_nn3
    s_mov_b64 exec, 1
    global_store_dwordx2 v152, v[154:155], s[98:99] sc1
    s_mov_b64 exec, -1
    L_nn3:
    ds_read_b64_tr_b16 v[128:129], v120
    ds_read_b64_tr_b16 v[130:131], v120 offset:256
    ds_read_b64_tr_b16 v[132:133], v120 offset:32
    ds_read_b64_tr_b16 v[134:135], v120 offset:288
    v_dot2_f32_bf16 v124, v112, v136, v124
    v_dot2_f32_bf16 v125, v112, v112, v125
    v_dot2_f32_bf16 v126, v160, v136, v126
    v_dot2_f32_bf16 v127, v160, v160, v127
    v_dot2_f32_bf16 v124, v113, v136, v124
    v_dot2_f32_bf16 v125, v113, v113, v125
    v_dot2_f32_bf16 v126, v161, v136, v126
    v_dot2_f32_bf16 v127, v161, v161, v127
    v_dot2_f32_bf16 v124, v114, v136, v124
    v_dot2_f32_bf16 v125, v114, v114, v125
    v_dot2_f32_bf16 v126, v162, v136, v126
    v_dot2_f32_bf16 v127, v162, v162, v127
    v_dot2_f32_bf16 v124, v115, v136, v124
    v_dot2_f32_bf16 v125, v115, v115, v125
    v_dot2_f32_bf16 v126, v163, v136, v126
    v_dot2_f32_bf16 v127, v163, v163, v127
    s_lshr_b32 s4, s2, 2
    s_lshl_b32 s4, s4, 15
    s_and_b32 s5, s52, 15
    s_lshl_b32 s5, s5, 11
    s_add_u32 s4, s4, s5
    s_add_u32 s4, s4, 0
    v_lshlrev_b32 v121, 6, v118
    v_lshl_add_u32 v121, v117, 4, v121
    s_waitcnt lgkmcnt(0)
    buffer_store_dwordx4 v[128:131], v121, s[8:11], s4 offen sc1
    buffer_store_dwordx4 v[132:135], v121, s[8:11], s4 offen offset:1024 sc1
    v_add_f32 v124, v124, v124 quad_perm:[1,0,3,2] row_mask:0xf bank_mask:0xf
    v_add_f32 v125, v125, v125 quad_perm:[1,0,3,2] row_mask:0xf bank_mask:0xf
    v_add_f32 v126, v126, v126 quad_perm:[1,0,3,2] row_mask:0xf bank_mask:0xf
    v_add_f32 v127, v127, v127 quad_perm:[1,0,3,2] row_mask:0xf bank_mask:0xf
    v_add_f32 v124, v124, v124 quad_perm:[2,3,0,1] row_mask:0xf bank_mask:0xf
    v_add_f32 v125, v125, v125 quad_perm:[2,3,0,1] row_mask:0xf bank_mask:0xf
    v_add_f32 v126, v126, v126 quad_perm:[2,3,0,1] row_mask:0xf bank_mask:0xf
    v_add_f32 v127, v127, v127 quad_perm:[2,3,0,1] row_mask:0xf bank_mask:0xf
    v_add_f32 v124, v124, v124 row_half_mirror row_mask:0xf bank_mask:0xf
    v_add_f32 v125, v125, v125 row_half_mirror row_mask:0xf bank_mask:0xf
    v_add_f32 v126, v126, v126 row_half_mirror row_mask:0xf bank_mask:0xf
    v_add_f32 v127, v127, v127 row_half_mirror row_mask:0xf bank_mask:0xf
    v_add_f32 v124, v124, v124 row_mirror row_mask:0xf bank_mask:0xf
    v_add_f32 v125, v125, v125 row_mirror row_mask:0xf bank_mask:0xf
    v_add_f32 v126, v126, v126 row_mirror row_mask:0xf bank_mask:0xf
    v_add_f32 v127, v127, v127 row_mirror row_mask:0xf bank_mask:0xf
    v_add_f32 v124, v124, v124 row_bcast:15 row_mask:0xa bank_mask:0xf
    v_add_f32 v125, v125, v125 row_bcast:15 row_mask:0xa bank_mask:0xf
    v_add_f32 v126, v126, v126 row_bcast:15 row_mask:0xa bank_mask:0xf
    v_add_f32 v127, v127, v127 row_bcast:15 row_mask:0xa bank_mask:0xf
    v_add_f32 v124, v124, v124 row_bcast:31 row_mask:0xc bank_mask:0xf
    v_add_f32 v125, v125, v125 row_bcast:31 row_mask:0xc bank_mask:0xf
    v_add_f32 v126, v126, v126 row_bcast:31 row_mask:0xc bank_mask:0xf
    v_add_f32 v127, v127, v127 row_bcast:31 row_mask:0xc bank_mask:0xf
    s_lshl_b32 s4, s52, 4
    s_add_u32 s4, s4, 8388608
    v_mov_b32 v138, 0
    v_mov_b32 v139, 0
    v_mov_b32 v140, -1
    v_mov_b32 v141, -1
    s_mov_b32 exec_lo, 0
    s_mov_b32 exec_hi, 0x80000000
    buffer_store_dwordx4 v[124:127], v152, s[8:11], s4 offen sc1
    s_mov_b64 exec, 0xffff
    s_lshl_b32 s4, s52, 7
    s_add_u32 s4, s4, 8404992
    v_lshlrev_b32 v121, 3, v1
    buffer_store_dwordx2 v[138:139], v121, s[8:11], s4 offen sc1
    s_mov_b64 exec, -1
    v_lshrrev_b32 v122, 1, v118
    v_lshlrev_b32 v122, 15, v122
    v_and_b32 v123, 1, v118
    v_lshl_add_u32 v122, v123, 5, v122
    v_lshl_add_u32 v122, v117, 3, v122
    s_lshl_b32 s4, s2, 7
    s_lshl_b32 s5, s45, 19
    s_add_u32 s4, s4, s5
    s_add_u32 s4, s4, 2097152
    s_add_u32 s5, s4, 0x40000
    buffer_store_dwordx2 v[140:141], v122, s[8:11], s4 offen sc1
    buffer_store_dwordx2 v[140:141], v122, s[8:11], s4 offen offset:64 sc1
    buffer_store_dwordx2 v[140:141], v122, s[8:11], s5 offen sc1
    buffer_store_dwordx2 v[140:141], v122, s[8:11], s5 offen offset:64 sc1
    s_branch L_sp_done
    L_sp_w:
    s_cmp_ge_u32 s52, 860
    s_cbranch_scc1 L_sp_done
    s_cmp_ge_u32 s52, 688
    s_cbranch_scc1 L_sp_wd
    v_lshl_add_u32 v120, v122, 3, v120
    v_lshlrev_b32 v120, 6, v120
    v_lshl_add_u32 v120, v121, 3, v120
    v_lshl_add_u32 v120, v123, 6, v120
    v_add_u32 v120, s53, v120
    s_lshr_b32 s4, s52, 4
    s_lshl_b32 s4, s4, 16
    s_and_b32 s5, s52, 15
    s_lshl_b32 s5, s5, 11
    s_add_u32 s4, s4, s5
    s_add_u32 s4, s4, 8650752
    s_add_u32 s5, s4, 0x8000
    s_waitcnt vmcnt(0)
    ds_read_b64_tr_b16 v[124:125], v120 offset:0
    ds_read_b64_tr_b16 v[126:127], v120 offset:256
    ds_read_b64_tr_b16 v[128:129], v120 offset:32
    ds_read_b64_tr_b16 v[130:131], v120 offset:288
    ds_read_b64_tr_b16 v[132:133], v120 offset:2048
    ds_read_b64_tr_b16 v[134:135], v120 offset:2304
    ds_read_b64_tr_b16 v[136:137], v120 offset:2080
    ds_read_b64_tr_b16 v[138:139], v120 offset:2336
    s_waitcnt lgkmcnt(6)
    buffer_store_dwordx4 v[124:127], v116, s[8:11], s4 offen offset:0 sc1
    s_waitcnt lgkmcnt(4)
    buffer_store_dwordx4 v[128:131], v116, s[8:11], s5 offen offset:0 sc1
    s_waitcnt lgkmcnt(2)
    buffer_store_dwordx4 v[132:135], v116, s[8:11], s4 offen offset:1024 sc1
    s_waitcnt lgkmcnt(0)
    buffer_store_dwordx4 v[136:139], v116, s[8:11], s5 offen offset:1024 sc1
    v_mov_b32 v140, 0
    v_mov_b32 v141, 0
    v_mov_b32 v142, 0x3f803f80
    v_dot2_f32_bf16 v140, v124, v142, v140
    v_dot2_f32_bf16 v140, v125, v142, v140
    v_dot2_f32_bf16 v140, v126, v142, v140
    v_dot2_f32_bf16 v140, v127, v142, v140
    v_dot2_f32_bf16 v141, v128, v142, v141
    v_dot2_f32_bf16 v141, v129, v142, v141
    v_dot2_f32_bf16 v141, v130, v142, v141
    v_dot2_f32_bf16 v141, v131, v142, v141
    v_dot2_f32_bf16 v140, v132, v142, v140
    v_dot2_f32_bf16 v140, v133, v142, v140
    v_dot2_f32_bf16 v140, v134, v142, v140
    v_dot2_f32_bf16 v140, v135, v142, v140
    v_dot2_f32_bf16 v141, v136, v142, v141
    v_dot2_f32_bf16 v141, v137, v142, v141
    v_dot2_f32_bf16 v141, v138, v142, v141
    v_dot2_f32_bf16 v141, v139, v142, v141
    s_lshr_b32 s4, s52, 4
    s_lshl_b32 s4, s4, 12
    s_and_b32 s5, s52, 15
    s_lshl_b32 s5, s5, 7
    v_permlane32_swap_b32 v140, v141
    s_add_u32 s4, s4, s5
    s_add_u32 s4, s4, 30408704
    v_and_b32 v121, 31, v1
    v_lshlrev_b32 v121, 2, v121
    v_lshl_add_u32 v121, v122, 11, v121
    v_add_f32 v140, v140, v141
    buffer_store_dword v140, v121, s[8:11], s4 offen sc1
    s_branch L_sp_done
    L_sp_wd:
    v_lshl_add_u32 v120, v122, 2, v120
    v_lshlrev_b32 v120, 9, v120
    v_lshl_add_u32 v120, v121, 3, v120
    v_lshl_add_u32 v120, v123, 1, v120
    v_add_u32 v120, s53, v120
    s_sub_u32 s4, s52, 688
    s_and_b32 s5, s4, 1
    s_lshr_b32 s4, s4, 1
    s_lshl_b32 s4, s4, 10
    s_mul_i32 s5, s5, 704512
    s_add_u32 s4, s4, s5
    s_add_u32 s4, s4, 11534336
    s_waitcnt vmcnt(0)
    ds_read_b64_tr_b16 v[168:169], v120 offset:0
    ds_read_b64_tr_b16 v[170:171], v120 offset:4096
    ds_read_b64_tr_b16 v[172:173], v120 offset:64
    ds_read_b64_tr_b16 v[174:175], v120 offset:4160
    ds_read_b64_tr_b16 v[176:177], v120 offset:128
    ds_read_b64_tr_b16 v[178:179], v120 offset:4224
    ds_read_b64_tr_b16 v[180:181], v120 offset:192
    ds_read_b64_tr_b16 v[182:183], v120 offset:4288
    s_waitcnt lgkmcnt(6)
    buffer_store_dwordx4 v[168:171], v116, s[8:11], s4 offen sc1
    s_add_u32 s4, s4, 88064
    s_waitcnt lgkmcnt(4)
    buffer_store_dwordx4 v[172:175], v116, s[8:11], s4 offen sc1
    s_add_u32 s4, s4, 88064
    s_waitcnt lgkmcnt(2)
    buffer_store_dwordx4 v[176:179], v116, s[8:11], s4 offen sc1
    s_add_u32 s4, s4, 88064
    s_waitcnt lgkmcnt(0)
    buffer_store_dwordx4 v[180:183], v116, s[8:11], s4 offen sc1
    s_add_u32 s4, s4, 88064
    ds_read_b64_tr_b16 v[184:185], v120 offset:256
    ds_read_b64_tr_b16 v[186:187], v120 offset:4352
    ds_read_b64_tr_b16 v[188:189], v120 offset:320
    ds_read_b64_tr_b16 v[190:191], v120 offset:4416
    ds_read_b64_tr_b16 v[192:193], v120 offset:384
    ds_read_b64_tr_b16 v[194:195], v120 offset:4480
    ds_read_b64_tr_b16 v[196:197], v120 offset:448
    ds_read_b64_tr_b16 v[198:199], v120 offset:4544
    s_waitcnt lgkmcnt(6)
    buffer_store_dwordx4 v[184:187], v116, s[8:11], s4 offen sc1
    s_add_u32 s4, s4, 88064
    s_waitcnt lgkmcnt(4)
    buffer_store_dwordx4 v[188:191], v116, s[8:11], s4 offen sc1
    s_add_u32 s4, s4, 88064
    s_waitcnt lgkmcnt(2)
    buffer_store_dwordx4 v[192:195], v116, s[8:11], s4 offen sc1
    s_add_u32 s4, s4, 88064
    s_waitcnt lgkmcnt(0)
    buffer_store_dwordx4 v[196:199], v116, s[8:11], s4 offen sc1
    s_add_u32 s4, s4, 88064
L_sp_done:
    s_waitcnt lgkmcnt(0)
    v_mul_f32 v68, v64, v20
    v_mul_f32 v69, v64, v21
    v_mul_f32 v70, v64, v22
    v_mul_f32 v71, v64, v23
    v_mul_f32 v72, v65, v20
    v_mul_f32 v73, v65, v21
    v_mul_f32 v74, v65, v22
    v_mul_f32 v75, v65, v23
    v_exp_f32 v68, v68
    v_exp_f32 v69, v69
    v_exp_f32 v70, v70
    v_exp_f32 v71, v71
    v_fract_f32 v72, v72
    v_fract_f32 v73, v73
    v_fract_f32 v74, v74
    v_fract_f32 v75, v75
    v_cos_f32 v76, v72
    v_cos_f32 v77, v73
    v_cos_f32 v78, v74
    v_cos_f32 v79, v75
    v_sin_f32 v4, v72
    v_sin_f32 v5, v73
    v_sin_f32 v6, v74
    v_sin_f32 v7, v75
    v_mul_f32 v8, v71, v66
    v_mul_f32 v9, v71, v67
    v_fma_mixlo_f16 v99, v68, v76, 0
    v_fma_mixlo_f16 v103, v69, v77, 0
    v_fma_mixlo_f16 v107, v70, v78, 0
    v_mul_f32 v10, v8, v79
    v_mul_f32 v11, v8, v7
    v_fma_mixhi_f16 v99, v68, v4, 0
    v_fma_mixhi_f16 v103, v69, v5, 0
    v_fma_mixhi_f16 v107, v70, v6, 0
    v_fma_mixlo_f16 v111, -v9, v7, v10
    s_nop 0
    v_fma_mixhi_f16 v111, -v9, v79, -v11
    s_mul_i32 s5, s45, 3072
    s_add_u32 s5, s5, s34
    s_add_u32 s5, s5, 2048
    v_lshl_add_u32 v12, v1, 4, s5
    v_mfma_f32_16x16x32_f16 v[24:27], v[96:99], v[108:111], v[24:27]
    v_mfma_f32_16x16x32_f16 v[28:31], v[100:103], v[108:111], v[28:31]
    v_mfma_f32_16x16x32_f16 v[32:35], v[104:107], v[108:111], v[32:35]
    s_nop 7
    v_mul_f32 v24, s35, v24
    v_mul_f32 v25, s35, v25
    v_mul_f32 v26, s35, v26
    v_mul_f32 v27, s35, v27
    v_mul_f32 v28, s35, v28
    v_mul_f32 v29, s35, v29
    v_mul_f32 v30, s35, v30
    v_mul_f32 v31, s35, v31
    v_mul_f32 v32, s35, v32
    v_mul_f32 v33, s35, v33
    v_mul_f32 v34, s35, v34
    v_mul_f32 v35, s35, v35
    ds_write_b128 v12, v[24:27]
    ds_write_b128 v12, v[28:31] offset:1024
    ds_write_b128 v12, v[32:35] offset:2048
    v_lshl_add_u32 v12, v0, 4, s34
    v_lshrrev_b32 v13, 4, v1
    v_and_b32 v14, 15, v1
    v_lshl_add_u32 v14, v14, 4, s34
    s_waitcnt lgkmcnt(0)
    s_barrier
    global_load_dwordx2 v[156:157], v152, s[98:99] sc1
    s_cmp_eq_u32 s45, 3
    s_cbranch_scc1 L_kg_stage2
    ds_read_b128 v[24:27], v12 offset:2048
    ds_read_b128 v[28:31], v12 offset:5120
    ds_read_b128 v[32:35], v12 offset:8192
    ds_read_b128 v[36:39], v12 offset:11264
    s_cmp_eq_u32 s45, 1
    s_cbranch_scc1 L_kg_t1
    s_cmp_eq_u32 s45, 2
    s_cbranch_scc1 L_kg_t2
    v_lshrrev_b32 v15, 1, v13
    v_lshlrev_b32 v15, 8, v15
    v_and_b32 v16, 1, v13
    v_lshl_add_u32 v15, v16, 3, v15
    v_add_u32 v16, v15, v14
    v_add_u32 v17, 2, v16
    v_add_u32 v18, 4, v16
    v_add_u32 v19, 6, v16
    s_branch L_kg_w
    L_kg_t1:
    v_lshlrev_b32 v15, 8, v13
    v_add_u32 v15, 0x200, v15
    v_add_u32 v16, v15, v14
    v_add_u32 v17, 4, v16
    v_add_u32 v18, 8, v16
    v_add_u32 v19, 12, v16
    v_lshlrev_b32 v15, 9, v13
    v_add_u32 v15, v15, v14
    v_add_u32 v20, 8, v15
    v_add_u32 v21, 0x100, v15
    v_add_u32 v22, 0x108, v15
    v_cmp_gt_u32 vcc, 2, v13
    s_nop 1
    v_cndmask_b32 v16, v15, v16, vcc
    v_cndmask_b32 v17, v20, v17, vcc
    v_cndmask_b32 v18, v21, v18, vcc
    v_cndmask_b32 v19, v22, v19, vcc
    s_branch L_kg_w
    L_kg_t2:
    v_lshlrev_b32 v15, 10, v13
    v_add_u32 v15, 0x800, v15
    v_add_u32 v16, v15, v14
    v_add_u32 v17, 0x100, v16
    v_add_u32 v18, 0x200, v16
    v_add_u32 v19, 0x300, v16
    L_kg_w:
    s_waitcnt lgkmcnt(0)
    v_pk_add_f32 v[24:25], v[24:25], v[28:29]
    v_pk_add_f32 v[26:27], v[26:27], v[30:31]
    v_pk_add_f32 v[32:33], v[32:33], v[36:37]
    v_pk_add_f32 v[34:35], v[34:35], v[38:39]
    v_pk_add_f32 v[24:25], v[24:25], v[32:33]
    v_pk_add_f32 v[26:27], v[26:27], v[34:35]
    v_cvt_pk_bf16_f32 v24, v24, v25
    v_cvt_pk_bf16_f32 v26, v26, v27
    ds_write_b16 v16, v24 offset:14336
    ds_write_b16_d16_hi v17, v24 offset:14336
    ds_write_b16 v18, v26 offset:14336
    ds_write_b16_d16_hi v19, v26 offset:14336
    L_kg_stage2:
    v_lshlrev_b32 v12, 4, v0
    v_sub_u32 v13, 4094, v12
    v_subrev_u32 v40, 0, v13
    v_subrev_u32 v41, 2, v13
    v_subrev_u32 v42, 4, v13
    v_subrev_u32 v43, 6, v13
    v_subrev_u32 v44, 8, v13
    v_subrev_u32 v45, 10, v13
    v_subrev_u32 v46, 12, v13
    v_subrev_u32 v47, 14, v13
    v_subrev_u32 v48, 16, v13
    v_subrev_u32 v49, 18, v13
    v_max_i32 v48, 0, v48
    v_max_i32 v49, 0, v49
    v_cvt_f32_u32 v40, v40
    v_cvt_f32_u32 v41, v41
    v_cvt_f32_u32 v42, v42
    v_cvt_f32_u32 v43, v43
    v_cvt_f32_u32 v44, v44
    v_cvt_f32_u32 v45, v45
    v_cvt_f32_u32 v46, v46
    v_cvt_f32_u32 v47, v47
    v_cvt_f32_u32 v48, v48
    v_cvt_f32_u32 v49, v49
    v_cvt_pk_bf16_f32 v52, v40, v41
    v_cvt_pk_bf16_f32 v54, v42, v43
    v_cvt_pk_bf16_f32 v56, v44, v45
    v_cvt_pk_bf16_f32 v58, v46, v47
    v_cvt_pk_bf16_f32 v60, v48, v49
    v_and_b32 v53, 0xffff0000, v52
    v_lshlrev_b32 v52, 16, v52
    v_and_b32 v55, 0xffff0000, v54
    v_lshlrev_b32 v54, 16, v54
    v_and_b32 v57, 0xffff0000, v56
    v_lshlrev_b32 v56, 16, v56
    v_and_b32 v59, 0xffff0000, v58
    v_lshlrev_b32 v58, 16, v58
    v_lshlrev_b32 v60, 16, v60
    v_cvt_u32_f32 v52, v52
    v_cvt_u32_f32 v53, v53
    v_cvt_u32_f32 v54, v54
    v_cvt_u32_f32 v55, v55
    v_cvt_u32_f32 v56, v56
    v_cvt_u32_f32 v57, v57
    v_cvt_u32_f32 v58, v58
    v_cvt_u32_f32 v59, v59
    v_cvt_u32_f32 v60, v60
    v_add_u32 v52, s34, v52
    v_add_u32 v53, s34, v53
    v_add_u32 v54, s34, v54
    v_add_u32 v55, s34, v55
    v_add_u32 v56, s34, v56
    v_add_u32 v57, s34, v57
    v_add_u32 v58, s34, v58
    v_add_u32 v59, s34, v59
    v_add_u32 v60, s34, v60
    s_waitcnt lgkmcnt(0)
    s_barrier
    ds_read_u16 v24, v52 offset:14336
    ds_read_u16 v25, v53 offset:14336
    ds_read_u16 v26, v54 offset:14336
    ds_read_u16 v27, v55 offset:14336
    ds_read_u16 v28, v56 offset:14336
    ds_read_u16 v29, v57 offset:14336
    ds_read_u16 v30, v58 offset:14336
    ds_read_u16 v31, v59 offset:14336
    ds_read_u16 v32, v60 offset:14336
    s_and_b32 s7, s3, 4
    v_mov_b32 v158, 131136
    v_add_u32 v153, s7, v158
    v_mov_b32 v159, 1
    s_mov_b32 s6, 0
    s_waitcnt vmcnt(0)
    s_mov_b64 exec, 1
    ds_add_rtn_u32 v159, v153, v159 offset:4
    s_waitcnt lgkmcnt(0)
    v_readfirstlane_b32 s7, v159
    s_mov_b64 exec, -1
    s_cmp_lg_u32 s7, 3
    s_cbranch_scc1 L_kg_np
    s_branch L_nc
    L_nq:
    global_load_dwordx2 v[156:157], v152, s[98:99] sc1
    s_add_u32 s6, s6, 1
    s_waitcnt vmcnt(0)
    L_nc:
    v_readfirstlane_b32 s7, v157
    s_cmp_ge_u32 s6, 400000
    s_cbranch_scc1 L_ne
    s_cmp_eq_u32 s7, 1
    s_cbranch_scc0 L_nq
    L_ne:
    ds_write_b32 v158, v156
    s_lshl_b32 s6, s2, 2
    s_add_u32 s6, s6, 8536064
    s_cmp_lt_u32 s3, 4
    s_cselect_b32 s7, 9216, 0
    s_add_u32 s6, s6, s7
    v_lshlrev_b32 v159, 10, v1
    s_mov_b64 exec, 0xff
    buffer_store_dword v156, v159, s[8:11], s6 offen sc1
    s_mov_b64 exec, -1
    L_kg_np:
    s_mul_i32 s5, s44, 8256
    s_add_u32 s5, s5, 13107200
    v_mov_b32 v48, 0
    v_mov_b32 v49, 0
    v_mov_b32 v50, 0
    v_mov_b32 v51, 0
    v_add_u32 v13, 4128, v12
    v_cmp_ne_u32 vcc, 0xff, v0
    s_nop 0
    s_waitcnt lgkmcnt(0)
    v_cndmask_b32 v32, 0, v32, vcc
    v_lshl_or_b32 v40, v25, 16, v24
    v_lshl_or_b32 v41, v27, 16, v26
    v_lshl_or_b32 v42, v29, 16, v28
    v_lshl_or_b32 v43, v31, 16, v30
    v_lshl_or_b32 v44, v26, 16, v25
    v_lshl_or_b32 v45, v28, 16, v27
    v_lshl_or_b32 v46, v30, 16, v29
    v_lshl_or_b32 v47, v32, 16, v31
    buffer_store_dwordx4 v[40:43], v12, s[8:11], s5 offen
    buffer_store_dwordx4 v[44:47], v13, s[8:11], s5 offen
    v_cmp_gt_u32 vcc, 2, v0
    s_and_saveexec_b64 s[6:7], vcc
    s_cbranch_execz L_kg_z
    v_add_u32 v12, 4096, v12
    v_add_u32 v13, 4096, v13
    buffer_store_dwordx4 v[48:51], v12, s[8:11], s5 offen
    buffer_store_dwordx4 v[48:51], v13, s[8:11], s5 offen
    L_kg_z:
    s_mov_b64 exec, -1
    s_waitcnt vmcnt(0) lgkmcnt(0)
    s_barrier
    s_mov_b32 s86, 0
    s_mov_b32 s87, 2097152
    s_mov_b32 s88, 8388608
    s_mov_b32 s89, 8421376
    s_mov_b32 s90, 17825792
    s_mov_b32 s91, 8462336
    s_mov_b32 s92, 4194304
    s_mov_b32 s93, 0
    s_mov_b32 s94, 8486912
    s_mov_b32 s95, 2
L_layer:
    v_mbcnt_lo_u32_b32 v1, -1, 0
    v_mbcnt_hi_u32_b32 v1, -1, v1
    s_lshl_b32 s4, s3, 6
    v_add_u32 v0, s4, v1
    v_lshlrev_b32 v3, 4, v1
    s_lshl_b32 s4, s2, 1
    s_lshr_b32 s5, s3, 2
    s_and_b32 s6, s3, 3
    s_add_u32 s7, s4, s5
    s_mul_i32 s28, s7, 8256
    s_add_u32 s28, s28, 13107200
    s_bitcmp1_b32 s6, 0
    s_cselect_b32 s13, 0, 4128
    s_add_u32 s28, s28, s13
    s_cmp_lt_u32 s6, 2
    s_cselect_b32 s13, 4, 0
    s_add_u32 s28, s28, s13
    s_mul_i32 s13, s5, 16640
    s_mul_i32 s14, s6, 4160
    s_add_u32 s13, s13, s14
    s_add_u32 s13, s13, 9152
    s_mov_b32 m0, s13
    s_lshl_b32 s12, s7, 1
    buffer_load_dwordx4 v3, s[8:11], s28 offen offset:0 lds
    buffer_load_dwordx4 v3, s[8:11], s28 offen offset:1024 lds
    buffer_load_dwordx4 v3, s[8:11], s28 offen offset:2048 lds
    buffer_load_dwordx4 v3, s[8:11], s28 offen offset:3072 lds
    v_mov_b32 v9, s12
    global_load_ushort v52, v9, s[16:17]
    v_lshlrev_b32 v4, 3, v0
    v_lshlrev_b32 v53, 5, v0
    v_lshrrev_b32 v54, 3, v0
    v_and_b32 v7, 7, v0
    v_lshlrev_b32 v54, 15, v54
    v_lshl_add_u32 v54, v7, 3, v54
    v_and_b32 v7, 15, v1
    v_lshrrev_b32 v8, 4, v1
    v_lshlrev_b32 v6, 5, v7
    v_lshl_add_u32 v6, v8, 3, v6
    v_lshrrev_b32 v5, 1, v7
    v_lshlrev_b32 v5, 15, v5
    v_and_b32 v9, 1, v7
    v_lshl_add_u32 v5, v9, 5, v5
    v_lshl_add_u32 v5, v8, 3, v5
    s_lshl_b32 s30, s4, 6
    s_add_u32 s30, s30, s86
    s_lshl_b32 s12, s7, 6
    s_lshl_b32 s14, s6, 19
    s_add_u32 s12, s12, s14
    s_add_u32 s26, s12, s87
    s_add_u32 s27, s26, 0x40000
    s_add_u32 s31, s12, s86
    s_add_u32 s32, s31, 0x40000
    v_mov_b32 v12, 0
    v_mov_b32 v13, 0
    v_mov_b32 v14, 0
    v_mov_b32 v15, 0
    s_add_u32 s13, s13, 4096
    v_add_u32 v9, s13, v3
    s_mul_i32 s13, s5, 4576
    v_add_u32 v10, s13, v3
    v_cmp_gt_u32 vcc, 2, v1
    s_and_saveexec_b64 s[28:29], vcc
    ds_write_b128 v9, v[12:15]
    s_mov_b64 exec, s[28:29]
    v_cmp_gt_u32 vcc, 30, v1
    s_and_saveexec_b64 s[28:29], vcc
    ds_write_b128 v10, v[12:15]
    s_mov_b64 exec, s[28:29]
    v_and_b32 v9, 3, v7
    v_mul_u32_u24 v9, 4160, v9
    v_lshrrev_b32 v10, 2, v7
    v_lshlrev_b32 v10, 3, v10
    v_sub_u32 v9, v9, v10
    v_lshl_add_u32 v9, v8, 4, v9
    s_mul_i32 s13, s5, 16640
    s_add_u32 s13, s13, 9176
    s_lshl_b32 s14, s6, 7
    s_sub_u32 s13, s13, s14
    v_add_u32 v10, s13, v9
    v_lshlrev_b32 v11, 5, v7
    v_lshl_add_u32 v11, v8, 4, v11
    s_mul_i32 s13, s5, 4576
    s_add_u32 s13, s13, 384
    s_sub_u32 s13, s13, s14
    v_add_u32 v11, s13, v11
    s_mov_b32 s24, 0x3b000000
    s_mov_b32 s25, 0x3727c5ac
    v_mov_b32 v16, 0
    v_mov_b32 v17, 0
    v_mov_b32 v18, 0
    v_mov_b32 v19, 0
    v_mov_b32 v20, 0
    v_mov_b32 v21, 0
    v_mov_b32 v22, 0
    v_mov_b32 v23, 0
    v_mov_b32 v24, 0
    v_mov_b32 v25, 0
    v_mov_b32 v26, 0
    v_mov_b32 v27, 0
    v_mov_b32 v28, 0
    v_mov_b32 v29, 0
    v_mov_b32 v30, 0
    v_mov_b32 v31, 0
    v_mov_b32 v32, 0
    v_mov_b32 v33, 0
    v_mov_b32 v34, 0
    v_mov_b32 v35, 0
    v_mov_b32 v36, 0
    v_mov_b32 v37, 0
    v_mov_b32 v38, 0
    v_mov_b32 v39, 0
    v_mov_b32 v40, 0
    v_mov_b32 v41, 0
    v_mov_b32 v42, 0
    v_mov_b32 v43, 0
    v_mov_b32 v44, 0
    v_mov_b32 v45, 0
    v_mov_b32 v46, 0
    v_mov_b32 v47, 0
    s_and_b32 s52, s2, 7
    s_lshr_b32 s53, s2, 3
    s_mul_i32 s55, s52, 30
    s_add_u32 s55, s55, s53
    s_sub_u32 s55, s55, 2
    s_cmp_ge_u32 s52, 6
    s_cselect_b32 s53, 1, 0
    s_add_u32 s55, s55, s53
    s_cmp_eq_u32 s52, 7
    s_cselect_b32 s53, 1, 0
    s_add_u32 s55, s55, s53
    s_cmp_ge_u32 s55, 88
    s_cselect_b32 s54, 88, 0
    s_cselect_b32 s53, 4, 0
    s_sub_u32 s12, s55, s54
    s_lshr_b32 s52, s12, 2
    s_and_b32 s12, s12, 3
    s_add_u32 s53, s53, s12
    s_sub_u32 s12, s55, 176
    s_mul_i32 s13, s12, 171
    s_lshr_b32 s13, s13, 9
    s_mul_i32 s54, s13, 3
    s_sub_u32 s54, s12, s54
    s_add_u32 s54, s54, 8
    s_cmp_ge_u32 s55, 176
    s_cselect_b32 s52, s13, s52
    s_cselect_b32 s53, s54, s53
    s_lshl_b32 s54, s53, 3
    s_add_u32 s54, s54, s3
    s_lshl_b32 s55, s54, 15
    s_add_u32 s55, s55, 8650752
    s_mov_b32 s20, s18
    s_mov_b32 s21, s19
    s_mov_b32 s23, 0x00020000
    s_cmp_lt_u32 s2, 14
    s_cselect_b32 s22, 0, s10
    s_cselect_b32 s55, 0, s55
    v_mov_b32 v9, 131072
    ds_write_b128 v9, v[12:15]
    ds_write_b128 v9, v[12:15] offset:16
    ds_write_b128 v9, v[12:15] offset:32
    ds_write_b128 v9, v[12:15] offset:48
    s_cmp_lg_u32 s3, 0
    s_cbranch_scc1 L_in_d
    s_mov_b32 s13, 0
    v_mov_b32 v56, 131136
    ds_read_b32 v60, v56
    s_and_b32 s15, s2, 7
    s_lshl_b32 s15, s15, 10
    s_cmp_eq_u32 s93, 1
    s_cselect_b32 s14, 0, 32768
    s_add_u32 s15, s15, s14
    s_add_u32 s15, s15, 8503296
    s_waitcnt lgkmcnt(0)
    L_in_b:
    buffer_load_dwordx4 v[56:59], v3, s[8:11], s15 offen sc1
    s_add_u32 s13, s13, 1
    s_waitcnt vmcnt(0)
    v_xor_b32 v56, v56, v60
    v_xor_b32 v57, v57, v60
    v_xor_b32 v58, v58, v60
    v_xor_b32 v59, v59, v60
    v_or3_b32 v56, v56, v57, v58
    v_or_b32 v56, v56, v59
    v_cmp_ne_u32 vcc, 0, v56
    s_cmp_eq_u64 vcc, 0
    s_cbranch_scc1 L_in_d
    s_cmp_ge_u32 s13, 400000
    s_cbranch_scc1 L_in_d
    s_sleep 4
    s_branch L_in_b
    L_in_d:
    s_barrier
    buffer_load_dwordx4 v[64:67], v53, s[8:11], s88 offen sc1
    buffer_load_dwordx4 v[68:71], v53, s[8:11], s88 offen offset:16 sc1
    buffer_load_dwordx2 v[72:73], v54, s[8:11], s30 offen sc1
    buffer_load_dwordx2 v[74:75], v54, s[8:11], s30 offen offset:64 sc1
    buffer_load_dwordx2 v[48:49], v5, s[8:11], s31 offen sc1
    buffer_load_dwordx2 v[50:51], v5, s[8:11], s32 offen sc1
    s_waitcnt vmcnt(4)
    v_mul_f32 v64, s24, v64
    v_mul_f32 v65, s24, v65
    v_mul_f32 v66, s24, v66
    v_mul_f32 v67, s24, v67
    v_mul_f32 v68, s24, v68
    v_mul_f32 v69, s24, v69
    v_mul_f32 v70, s24, v70
    v_mul_f32 v71, s24, v71
    v_fma_f32 v65, -v64, v64, v65
    v_fma_f32 v67, -v66, v66, v67
    v_fma_f32 v69, -v68, v68, v69
    v_fma_f32 v71, -v70, v70, v71
    v_max_f32 v65, 0, v65
    v_max_f32 v67, 0, v67
    v_max_f32 v69, 0, v69
    v_max_f32 v71, 0, v71
    v_cvt_pk_bf16_f32 v76, v64, v66
    v_cvt_pk_bf16_f32 v77, v68, v70
    v_cvt_pk_bf16_f32 v78, v65, v67
    v_cvt_pk_bf16_f32 v79, v69, v71
    v_lshlrev_b32 v84, 16, v78
    v_and_b32 v85, 0xffff0000, v78
    v_lshlrev_b32 v86, 16, v79
    v_and_b32 v87, 0xffff0000, v79
    v_lshlrev_b32 v80, 16, v76
    v_and_b32 v81, 0xffff0000, v76
    v_lshlrev_b32 v82, 16, v77
    v_and_b32 v83, 0xffff0000, v77
    v_add_f32 v84, s25, v84
    v_add_f32 v85, s25, v85
    v_add_f32 v86, s25, v86
    v_add_f32 v87, s25, v87
    v_cvt_pk_bf16_f32 v78, v84, v85
    v_cvt_pk_bf16_f32 v79, v86, v87
    v_lshlrev_b32 v84, 16, v78
    v_and_b32 v85, 0xffff0000, v78
    v_lshlrev_b32 v86, 16, v79
    v_and_b32 v87, 0xffff0000, v79
    v_sqrt_f32 v84, v84
    v_sqrt_f32 v85, v85
    v_sqrt_f32 v86, v86
    v_sqrt_f32 v87, v87
    s_waitcnt vmcnt(2)
    v_lshlrev_b32 v88, 16, v72
    v_and_b32 v89, 0xffff0000, v72
    v_lshlrev_b32 v90, 16, v73
    v_and_b32 v91, 0xffff0000, v73
    v_lshlrev_b32 v92, 16, v74
    v_and_b32 v93, 0xffff0000, v74
    v_lshlrev_b32 v94, 16, v75
    v_and_b32 v95, 0xffff0000, v75
    v_cvt_pk_bf16_f32 v78, v84, v85
    v_cvt_pk_bf16_f32 v79, v86, v87
    v_pk_add_f32 v[88:89], v[88:89], v[80:81] neg_lo:[0,1] neg_hi:[0,1]
    v_pk_add_f32 v[90:91], v[90:91], v[82:83] neg_lo:[0,1] neg_hi:[0,1]
    v_pk_add_f32 v[92:93], v[92:93], v[80:81] neg_lo:[0,1] neg_hi:[0,1]
    v_pk_add_f32 v[94:95], v[94:95], v[82:83] neg_lo:[0,1] neg_hi:[0,1]
    v_lshlrev_b32 v84, 16, v78
    v_and_b32 v85, 0xffff0000, v78
    v_lshlrev_b32 v86, 16, v79
    v_and_b32 v87, 0xffff0000, v79
    v_cvt_pk_bf16_f32 v72, v88, v89
    v_cvt_pk_bf16_f32 v73, v90, v91
    v_cvt_pk_bf16_f32 v74, v92, v93
    v_cvt_pk_bf16_f32 v75, v94, v95
    v_rcp_f32 v84, v84
    v_rcp_f32 v85, v85
    v_rcp_f32 v86, v86
    v_rcp_f32 v87, v87
    v_lshlrev_b32 v88, 16, v72
    v_and_b32 v89, 0xffff0000, v72
    v_lshlrev_b32 v90, 16, v73
    v_and_b32 v91, 0xffff0000, v73
    v_lshlrev_b32 v92, 16, v74
    v_and_b32 v93, 0xffff0000, v74
    v_lshlrev_b32 v94, 16, v75
    v_and_b32 v95, 0xffff0000, v75
    v_pk_mul_f32 v[88:89], v[88:89], v[84:85]
    v_pk_mul_f32 v[90:91], v[90:91], v[86:87]
    v_pk_mul_f32 v[92:93], v[92:93], v[84:85]
    v_pk_mul_f32 v[94:95], v[94:95], v[86:87]
    v_cvt_pk_bf16_f32 v72, v88, v89
    v_cvt_pk_bf16_f32 v73, v90, v91
    ds_write_b64 v4, v[72:73] offset:480
    v_cvt_pk_bf16_f32 v74, v92, v93
    v_cvt_pk_bf16_f32 v75, v94, v95
    ds_write_b64 v4, v[74:75] offset:5056
    s_lshl_b32 s13, s93, 3
    s_add_u32 s13, s13, s3
    s_cmp_lg_u32 s13, 1
    s_cbranch_scc1 L_pw_d
    s_mov_b32 s13, 0
    v_mov_b32 v56, 131136
    ds_read_b32 v60, v56
    s_and_b32 s15, s2, 7
    s_lshl_b32 s15, s15, 10
    s_add_u32 s15, s15, 8545280
    s_waitcnt lgkmcnt(0)
    L_pw_b:
    buffer_load_dwordx4 v[56:59], v3, s[8:11], s15 offen sc1
    s_add_u32 s13, s13, 1
    s_waitcnt vmcnt(0)
    v_xor_b32 v56, v56, v60
    v_xor_b32 v57, v57, v60
    v_xor_b32 v58, v58, v60
    v_xor_b32 v59, v59, v60
    v_or3_b32 v56, v56, v57, v58
    v_or_b32 v56, v56, v59
    v_cmp_ne_u32 vcc, 0, v56
    s_cmp_eq_u64 vcc, 0
    s_cbranch_scc1 L_pw_d
    s_cmp_ge_u32 s13, 400000
    s_cbranch_scc1 L_pw_d
    s_sleep 4
    s_branch L_pw_b
    L_pw_d:
    s_lshl_b32 s13, s93, 3
    s_add_u32 s13, s13, s3
    s_lshl_b32 s14, s2, 4
    s_add_u32 s13, s13, s14
    s_cmp_lg_u32 s13, 1
    s_cbranch_scc1 L_dz
    s_mov_b64 exec, 1
    global_store_dwordx2 v12, v[12:13], s[98:99] sc1
    s_mov_b64 exec, -1
    L_dz:
    s_waitcnt vmcnt(0) lgkmcnt(0)
    s_barrier
    ds_read_b64 v[56:57], v10 offset:4032
    ds_read_b64 v[58:59], v10 offset:4040
    ds_read_b128 v[60:63], v11 offset:64
    ds_read_b64 v[64:65], v10 offset:3520
    ds_read_b64 v[66:67], v10 offset:3528
    ds_read_b128 v[68:71], v11 offset:576
    ds_read_b64 v[72:73], v10 offset:3008
    ds_read_b64 v[74:75], v10 offset:3016
    ds_read_b128 v[76:79], v11 offset:1088
    ds_read_b64 v[80:81], v10 offset:2496
    ds_read_b64 v[82:83], v10 offset:2504
    ds_read_b128 v[84:87], v11 offset:1600
    v_mov_b32 v164, -1
    v_mov_b32 v165, -1
    v_mov_b32 v166, -1
    v_mov_b32 v167, -1
    s_mov_b32 s48, s18
    s_mov_b32 s49, s19
    s_mov_b32 s51, 0x00020000
    s_cmp_eq_u32 s93, 1
    s_cselect_b32 s50, 0, s10
    s_add_u32 s15, s26, 4194304
    buffer_store_dwordx2 v[164:165], v5, s[48:51], s15 offen sc1
    s_add_u32 s15, s27, 4194304
    buffer_store_dwordx2 v[164:165], v5, s[48:51], s15 offen sc1
    s_nop 1
    s_waitcnt lgkmcnt(9)
    v_mfma_f32_16x16x32_bf16 v[16:19], v[56:59], v[60:63], v[16:19]
    ds_read_b64 v[88:89], v10 offset:1984
    ds_read_b64 v[90:91], v10 offset:1992
    s_waitcnt lgkmcnt(8)
    v_mfma_f32_16x16x32_bf16 v[20:23], v[56:59], v[68:71], v[20:23]
    s_add_u32 s14, s55, 0
    buffer_load_dwordx4 v[168:171], v3, s[20:23], s14 offen offset:0 sc1
    ds_read_b128 v[92:95], v11 offset:2112
    v_mfma_f32_16x16x32_bf16 v[20:23], v[64:67], v[60:63], v[20:23]
    ds_read_b64 v[96:97], v10 offset:1472
    ds_read_b64 v[98:99], v10 offset:1480
    v_mfma_f32_16x16x32_bf16 v[24:27], v[64:67], v[68:71], v[24:27]
    ds_read_b128 v[100:103], v11 offset:2624
    s_waitcnt lgkmcnt(9)
    v_mfma_f32_16x16x32_bf16 v[24:27], v[56:59], v[76:79], v[24:27]
    s_add_u32 s14, s55, 0
    buffer_load_dwordx4 v[172:175], v3, s[20:23], s14 offen offset:1024 sc1
    ds_read_b64 v[104:105], v10 offset:960
    ds_read_b64 v[106:107], v10 offset:968
    v_mfma_f32_16x16x32_bf16 v[28:31], v[64:67], v[76:79], v[28:31]
    ds_read_b128 v[108:111], v11 offset:3136
    v_mfma_f32_16x16x32_bf16 v[24:27], v[72:75], v[60:63], v[24:27]
    ds_read_b64 v[112:113], v10 offset:448
    ds_read_b64 v[114:115], v10 offset:456
    v_mfma_f32_16x16x32_bf16 v[28:31], v[72:75], v[68:71], v[28:31]
    s_add_u32 s14, s55, 0
    buffer_load_dwordx4 v[176:179], v3, s[20:23], s14 offen offset:2048 sc1
    v_mfma_f32_16x16x32_bf16 v[32:35], v[72:75], v[76:79], v[32:35]
    s_waitcnt lgkmcnt(11)
    v_mfma_f32_16x16x32_bf16 v[28:31], v[56:59], v[84:87], v[28:31]
    ds_read_b128 v[116:119], v11 offset:3648
    v_mfma_f32_16x16x32_bf16 v[32:35], v[64:67], v[84:87], v[32:35]
    s_add_u32 s14, s55, 0
    buffer_load_dwordx4 v[180:183], v3, s[20:23], s14 offen offset:3072 sc1
    ds_read_b64 v[120:121], v10 offset:3968
    ds_read_b64 v[122:123], v10 offset:3976
    v_mfma_f32_16x16x32_bf16 v[36:39], v[72:75], v[84:87], v[36:39]
    v_mfma_f32_16x16x32_bf16 v[28:31], v[80:83], v[60:63], v[28:31]
    v_mfma_f32_16x16x32_bf16 v[32:35], v[80:83], v[68:71], v[32:35]
    s_add_u32 s14, s55, 4096
    buffer_load_dwordx4 v[184:187], v3, s[20:23], s14 offen offset:0 sc1
    v_mfma_f32_16x16x32_bf16 v[36:39], v[80:83], v[76:79], v[36:39]
    v_mfma_f32_16x16x32_bf16 v[40:43], v[80:83], v[84:87], v[40:43]
    s_waitcnt lgkmcnt(11)
    v_mfma_f32_16x16x32_bf16 v[32:35], v[56:59], v[92:95], v[32:35]
    s_add_u32 s14, s55, 4096
    buffer_load_dwordx4 v[188:191], v3, s[20:23], s14 offen offset:1024 sc1
    ds_read_b128 v[124:127], v11 offset:0
    v_mfma_f32_16x16x32_bf16 v[36:39], v[64:67], v[92:95], v[36:39]
    ds_read_b64 v[128:129], v10 offset:3456
    ds_read_b64 v[130:131], v10 offset:3464
    v_mfma_f32_16x16x32_bf16 v[40:43], v[72:75], v[92:95], v[40:43]
    v_mfma_f32_16x16x32_bf16 v[44:47], v[80:83], v[92:95], v[44:47]
    s_add_u32 s14, s55, 4096
    buffer_load_dwordx4 v[192:195], v3, s[20:23], s14 offen offset:2048 sc1
    v_mfma_f32_16x16x32_bf16 v[32:35], v[88:91], v[60:63], v[32:35]
    v_mfma_f32_16x16x32_bf16 v[36:39], v[88:91], v[68:71], v[36:39]
    v_mfma_f32_16x16x32_bf16 v[40:43], v[88:91], v[76:79], v[40:43]
    s_add_u32 s14, s55, 4096
    buffer_load_dwordx4 v[196:199], v3, s[20:23], s14 offen offset:3072 sc1
    v_mfma_f32_16x16x32_bf16 v[44:47], v[88:91], v[84:87], v[44:47]
    s_waitcnt lgkmcnt(11)
    v_mfma_f32_16x16x32_bf16 v[36:39], v[56:59], v[100:103], v[36:39]
    ds_read_b128 v[132:135], v11 offset:512
    v_mfma_f32_16x16x32_bf16 v[40:43], v[64:67], v[100:103], v[40:43]
    s_add_u32 s14, s55, 8192
    buffer_load_dwordx4 v[200:203], v3, s[20:23], s14 offen offset:0 sc1
    ds_read_b64 v[136:137], v10 offset:2944
    ds_read_b64 v[138:139], v10 offset:2952
    v_mfma_f32_16x16x32_bf16 v[44:47], v[72:75], v[100:103], v[44:47]
    v_mfma_f32_16x16x32_bf16 v[36:39], v[96:99], v[60:63], v[36:39]
    v_mfma_f32_16x16x32_bf16 v[40:43], v[96:99], v[68:71], v[40:43]
    s_add_u32 s14, s55, 8192
    buffer_load_dwordx4 v[204:207], v3, s[20:23], s14 offen offset:1024 sc1
    v_mfma_f32_16x16x32_bf16 v[44:47], v[96:99], v[76:79], v[44:47]
    s_waitcnt lgkmcnt(11)
    v_mfma_f32_16x16x32_bf16 v[40:43], v[56:59], v[108:111], v[40:43]
    ds_read_b128 v[140:143], v11 offset:1024
    v_mfma_f32_16x16x32_bf16 v[44:47], v[64:67], v[108:111], v[44:47]
    s_add_u32 s14, s55, 8192
    buffer_load_dwordx4 v[208:211], v3, s[20:23], s14 offen offset:2048 sc1
    ds_read_b64 v[144:145], v10 offset:2432
    ds_read_b64 v[146:147], v10 offset:2440
    v_mfma_f32_16x16x32_bf16 v[40:43], v[104:107], v[60:63], v[40:43]
    v_mfma_f32_16x16x32_bf16 v[44:47], v[104:107], v[68:71], v[44:47]
    s_waitcnt lgkmcnt(11)
    v_mfma_f32_16x16x32_bf16 v[44:47], v[56:59], v[116:119], v[44:47]
    s_add_u32 s14, s55, 8192
    buffer_load_dwordx4 v[212:215], v3, s[20:23], s14 offen offset:3072 sc1
    ds_read_b128 v[148:151], v11 offset:1536
    v_mfma_f32_16x16x32_bf16 v[44:47], v[112:115], v[60:63], v[44:47]
    ds_read_b64 v[152:153], v10 offset:1920
    ds_read_b64 v[154:155], v10 offset:1928
    s_waitcnt lgkmcnt(11)
    v_mfma_f32_16x16x32_bf16 v[16:19], v[120:123], v[124:127], v[16:19]
    ds_read_b128 v[156:159], v11 offset:2048
    s_waitcnt lgkmcnt(9)
    v_mfma_f32_16x16x32_bf16 v[20:23], v[120:123], v[132:135], v[20:23]
    s_add_u32 s14, s55, 12288
    buffer_load_dwordx4 v[216:219], v3, s[20:23], s14 offen offset:0 sc1
    ds_read_b64 v[160:161], v10 offset:1408
    ds_read_b64 v[162:163], v10 offset:1416
    v_mfma_f32_16x16x32_bf16 v[20:23], v[128:131], v[124:127], v[20:23]
    ds_read_b128 v[164:167], v11 offset:2560
    v_mfma_f32_16x16x32_bf16 v[24:27], v[128:131], v[132:135], v[24:27]
    ds_read_b64 v[80:81], v10 offset:896
    ds_read_b64 v[82:83], v10 offset:904
    s_waitcnt lgkmcnt(11)
    v_mfma_f32_16x16x32_bf16 v[24:27], v[120:123], v[140:143], v[24:27]
    s_add_u32 s14, s55, 12288
    buffer_load_dwordx4 v[220:223], v3, s[20:23], s14 offen offset:1024 sc1
    ds_read_b128 v[92:95], v11 offset:3072
    v_mfma_f32_16x16x32_bf16 v[28:31], v[128:131], v[140:143], v[28:31]
    ds_read_b64 v[88:89], v10 offset:384
    ds_read_b64 v[90:91], v10 offset:392
    v_mfma_f32_16x16x32_bf16 v[24:27], v[136:139], v[124:127], v[24:27]
    v_mfma_f32_16x16x32_bf16 v[28:31], v[136:139], v[132:135], v[28:31]
    s_add_u32 s14, s55, 12288
    buffer_load_dwordx4 v[224:227], v3, s[20:23], s14 offen offset:2048 sc1
    v_mfma_f32_16x16x32_bf16 v[32:35], v[136:139], v[140:143], v[32:35]
    s_waitcnt lgkmcnt(11)
    v_mfma_f32_16x16x32_bf16 v[28:31], v[120:123], v[148:151], v[28:31]
    ds_read_b128 v[84:87], v11 offset:3584
    v_mfma_f32_16x16x32_bf16 v[32:35], v[128:131], v[148:151], v[32:35]
    s_add_u32 s14, s55, 12288
    buffer_load_dwordx4 v[228:231], v3, s[20:23], s14 offen offset:3072 sc1
    v_mfma_f32_16x16x32_bf16 v[36:39], v[136:139], v[148:151], v[36:39]
    v_mfma_f32_16x16x32_bf16 v[28:31], v[144:147], v[124:127], v[28:31]
    v_mfma_f32_16x16x32_bf16 v[32:35], v[144:147], v[132:135], v[32:35]
    s_add_u32 s14, s55, 16384
    buffer_load_dwordx4 v[232:235], v3, s[20:23], s14 offen offset:0 sc1
    v_mfma_f32_16x16x32_bf16 v[36:39], v[144:147], v[140:143], v[36:39]
    v_mfma_f32_16x16x32_bf16 v[40:43], v[144:147], v[148:151], v[40:43]
    s_waitcnt lgkmcnt(9)
    v_mfma_f32_16x16x32_bf16 v[32:35], v[120:123], v[156:159], v[32:35]
    s_add_u32 s14, s55, 16384
    buffer_load_dwordx4 v[236:239], v3, s[20:23], s14 offen offset:1024 sc1
    v_mfma_f32_16x16x32_bf16 v[36:39], v[128:131], v[156:159], v[36:39]
    v_mfma_f32_16x16x32_bf16 v[40:43], v[136:139], v[156:159], v[40:43]
    v_mfma_f32_16x16x32_bf16 v[44:47], v[144:147], v[156:159], v[44:47]
    s_add_u32 s14, s55, 16384
    buffer_load_dwordx4 v[240:243], v3, s[20:23], s14 offen offset:2048 sc1
    v_mfma_f32_16x16x32_bf16 v[32:35], v[152:155], v[124:127], v[32:35]
    v_mfma_f32_16x16x32_bf16 v[36:39], v[152:155], v[132:135], v[36:39]
    v_mfma_f32_16x16x32_bf16 v[40:43], v[152:155], v[140:143], v[40:43]
    s_add_u32 s14, s55, 16384
    buffer_load_dwordx4 v[244:247], v3, s[20:23], s14 offen offset:3072 sc1
    v_mfma_f32_16x16x32_bf16 v[44:47], v[152:155], v[148:151], v[44:47]
    s_waitcnt lgkmcnt(6)
    v_mfma_f32_16x16x32_bf16 v[36:39], v[120:123], v[164:167], v[36:39]
    v_mfma_f32_16x16x32_bf16 v[40:43], v[128:131], v[164:167], v[40:43]
    s_add_u32 s14, s55, 20480
    buffer_load_dwordx4 v[248:251], v3, s[20:23], s14 offen offset:0 sc1
    v_mfma_f32_16x16x32_bf16 v[44:47], v[136:139], v[164:167], v[44:47]
    v_mfma_f32_16x16x32_bf16 v[36:39], v[160:163], v[124:127], v[36:39]
    v_mfma_f32_16x16x32_bf16 v[40:43], v[160:163], v[132:135], v[40:43]
    s_add_u32 s14, s55, 20480
    buffer_load_dwordx4 v[252:255], v3, s[20:23], s14 offen offset:1024 sc1
    v_mfma_f32_16x16x32_bf16 v[44:47], v[160:163], v[140:143], v[44:47]
    s_waitcnt lgkmcnt(3)
    v_mfma_f32_16x16x32_bf16 v[40:43], v[120:123], v[92:95], v[40:43]
    v_mfma_f32_16x16x32_bf16 v[44:47], v[128:131], v[92:95], v[44:47]
    v_mfma_f32_16x16x32_bf16 v[40:43], v[80:83], v[124:127], v[40:43]
    v_mfma_f32_16x16x32_bf16 v[44:47], v[80:83], v[132:135], v[44:47]
    s_waitcnt lgkmcnt(0)
    v_mfma_f32_16x16x32_bf16 v[44:47], v[120:123], v[84:87], v[44:47]
    v_mfma_f32_16x16x32_bf16 v[44:47], v[88:91], v[124:127], v[44:47]
    s_lshl_b32 s13, s5, 15
    s_lshl_b32 s14, s6, 10
    s_add_u32 s13, s13, s14
    s_add_u32 s13, s13, 42432
    v_add_u32 v9, s13, v3
    s_lshl_b32 s13, s5, 15
    s_lshl_b32 s14, s6, 13
    s_add_u32 s13, s13, s14
    s_add_u32 s13, s13, 42432
    v_add_u32 v12, s13, v3
    s_mul_i32 s13, s5, 4576
    s_lshl_b32 s14, s6, 10
    s_add_u32 s13, s13, s14
    s_add_u32 s13, s13, 480
    v_add_u32 v13, s13, v6
    ds_read_b64 v[88:89], v13
    ds_read_b64 v[90:91], v13 offset:512
    s_cmp_lg_u32 s6, 0
    s_cbranch_scc1 L_m_rv1
    ds_write_b128 v9, v[24:27] offset:8192
    ds_write_b128 v9, v[28:31] offset:12288
    ds_write_b128 v9, v[32:35] offset:16384
    ds_write_b128 v9, v[36:39] offset:20480
    ds_write_b128 v9, v[40:43] offset:24576
    ds_write_b128 v9, v[44:47] offset:28672
    v_mov_b32 v56, v16
    v_mov_b32 v57, v17
    v_mov_b32 v58, v18
    v_mov_b32 v59, v19
    v_mov_b32 v60, v20
    v_mov_b32 v61, v21
    v_mov_b32 v62, v22
    v_mov_b32 v63, v23
    v_add_u32 v92, 1024, v12
    v_add_u32 v93, 2048, v12
    v_add_u32 v94, 3072, v12
    s_branch L_m_ep
L_m_rv1:
    s_cmp_lg_u32 s6, 1
    s_cbranch_scc1 L_m_rv2
    ds_write_b128 v9, v[16:19] offset:0
    ds_write_b128 v9, v[20:23] offset:4096
    ds_write_b128 v9, v[32:35] offset:16384
    ds_write_b128 v9, v[36:39] offset:20480
    ds_write_b128 v9, v[40:43] offset:24576
    ds_write_b128 v9, v[44:47] offset:28672
    v_mov_b32 v56, v24
    v_mov_b32 v57, v25
    v_mov_b32 v58, v26
    v_mov_b32 v59, v27
    v_mov_b32 v60, v28
    v_mov_b32 v61, v29
    v_mov_b32 v62, v30
    v_mov_b32 v63, v31
    v_add_u32 v92, 0, v12
    v_add_u32 v93, 2048, v12
    v_add_u32 v94, 3072, v12
    s_branch L_m_ep
L_m_rv2:
    s_cmp_lg_u32 s6, 2
    s_cbranch_scc1 L_m_rv3
    ds_write_b128 v9, v[16:19] offset:0
    ds_write_b128 v9, v[20:23] offset:4096
    ds_write_b128 v9, v[24:27] offset:8192
    ds_write_b128 v9, v[28:31] offset:12288
    ds_write_b128 v9, v[40:43] offset:24576
    ds_write_b128 v9, v[44:47] offset:28672
    v_mov_b32 v56, v32
    v_mov_b32 v57, v33
    v_mov_b32 v58, v34
    v_mov_b32 v59, v35
    v_mov_b32 v60, v36
    v_mov_b32 v61, v37
    v_mov_b32 v62, v38
    v_mov_b32 v63, v39
    v_add_u32 v92, 0, v12
    v_add_u32 v93, 1024, v12
    v_add_u32 v94, 3072, v12
    s_branch L_m_ep
L_m_rv3:
    ds_write_b128 v9, v[16:19] offset:0
    ds_write_b128 v9, v[20:23] offset:4096
    ds_write_b128 v9, v[24:27] offset:8192
    ds_write_b128 v9, v[28:31] offset:12288
    ds_write_b128 v9, v[32:35] offset:16384
    ds_write_b128 v9, v[36:39] offset:20480
    v_mov_b32 v56, v40
    v_mov_b32 v57, v41
    v_mov_b32 v58, v42
    v_mov_b32 v59, v43
    v_mov_b32 v60, v44
    v_mov_b32 v61, v45
    v_mov_b32 v62, v46
    v_mov_b32 v63, v47
    v_add_u32 v92, 0, v12
    v_add_u32 v93, 1024, v12
    v_add_u32 v94, 2048, v12
L_m_ep:
    s_waitcnt lgkmcnt(6)
    v_lshlrev_b32 v52, 16, v52
    v_mov_b32 v53, v52
    v_lshlrev_b32 v96, 16, v88
    v_and_b32 v97, 0xffff0000, v88
    v_lshlrev_b32 v98, 16, v89
    v_and_b32 v99, 0xffff0000, v89
    v_lshlrev_b32 v100, 16, v90
    v_and_b32 v101, 0xffff0000, v90
    v_lshlrev_b32 v102, 16, v91
    v_and_b32 v103, 0xffff0000, v91
    v_pk_mul_f32 v[96:97], v[96:97], v[52:53]
    v_pk_mul_f32 v[98:99], v[98:99], v[52:53]
    v_pk_mul_f32 v[100:101], v[100:101], v[52:53]
    v_pk_mul_f32 v[102:103], v[102:103], v[52:53]
    v_cvt_pk_bf16_f32 v88, v96, v97
    v_cvt_pk_bf16_f32 v89, v98, v99
    v_cvt_pk_bf16_f32 v90, v100, v101
    v_cvt_pk_bf16_f32 v91, v102, v103
    s_waitcnt lgkmcnt(0)
    s_barrier
    ds_read_b128 v[64:67], v92 offset:0
    ds_read_b128 v[68:71], v93 offset:0
    ds_read_b128 v[72:75], v94 offset:0
    ds_read_b128 v[76:79], v92 offset:4096
    ds_read_b128 v[80:83], v93 offset:4096
    ds_read_b128 v[84:87], v94 offset:4096
    v_lshlrev_b32 v96, 16, v88
    v_and_b32 v97, 0xffff0000, v88
    v_lshlrev_b32 v98, 16, v89
    v_and_b32 v99, 0xffff0000, v89
    v_lshlrev_b32 v100, 16, v90
    v_and_b32 v101, 0xffff0000, v90
    v_lshlrev_b32 v102, 16, v91
    v_and_b32 v103, 0xffff0000, v91
    v_lshlrev_b32 v104, 16, v48
    v_and_b32 v105, 0xffff0000, v48
    v_lshlrev_b32 v106, 16, v49
    v_and_b32 v107, 0xffff0000, v49
    v_lshlrev_b32 v108, 16, v50
    v_and_b32 v109, 0xffff0000, v50
    v_lshlrev_b32 v110, 16, v51
    v_and_b32 v111, 0xffff0000, v51
    s_waitcnt lgkmcnt(3)
    v_pk_add_f32 v[56:57], v[56:57], v[64:65]
    v_pk_add_f32 v[68:69], v[68:69], v[72:73]
    v_pk_add_f32 v[58:59], v[58:59], v[66:67]
    v_pk_add_f32 v[70:71], v[70:71], v[74:75]
    v_pk_add_f32 v[56:57], v[56:57], v[68:69]
    v_pk_add_f32 v[58:59], v[58:59], v[70:71]
    s_waitcnt lgkmcnt(0)
    v_pk_add_f32 v[60:61], v[60:61], v[76:77]
    v_pk_add_f32 v[80:81], v[80:81], v[84:85]
    v_pk_add_f32 v[62:63], v[62:63], v[78:79]
    v_pk_add_f32 v[82:83], v[82:83], v[86:87]
    v_pk_add_f32 v[60:61], v[60:61], v[80:81]
    v_pk_add_f32 v[62:63], v[62:63], v[82:83]
    v_cvt_pk_bf16_f32 v64, v56, v57
    v_cvt_pk_bf16_f32 v65, v58, v59
    v_cvt_pk_bf16_f32 v66, v60, v61
    v_cvt_pk_bf16_f32 v67, v62, v63
    v_lshlrev_b32 v56, 16, v64
    v_and_b32 v57, 0xffff0000, v64
    v_lshlrev_b32 v58, 16, v65
    v_and_b32 v59, 0xffff0000, v65
    v_lshlrev_b32 v60, 16, v66
    v_and_b32 v61, 0xffff0000, v66
    v_lshlrev_b32 v62, 16, v67
    v_and_b32 v63, 0xffff0000, v67
    v_pk_add_f32 v[56:57], v[56:57], v[96:97]
    v_pk_add_f32 v[58:59], v[58:59], v[98:99]
    v_pk_add_f32 v[60:61], v[60:61], v[100:101]
    v_pk_add_f32 v[62:63], v[62:63], v[102:103]
    v_cvt_pk_bf16_f32 v64, v56, v57
    v_cvt_pk_bf16_f32 v65, v58, v59
    v_cvt_pk_bf16_f32 v66, v60, v61
    v_cvt_pk_bf16_f32 v67, v62, v63
    v_lshlrev_b32 v56, 16, v64
    v_and_b32 v57, 0xffff0000, v64
    v_lshlrev_b32 v58, 16, v65
    v_and_b32 v59, 0xffff0000, v65
    v_lshlrev_b32 v60, 16, v66
    v_and_b32 v61, 0xffff0000, v66
    v_lshlrev_b32 v62, 16, v67
    v_and_b32 v63, 0xffff0000, v67
    v_pk_add_f32 v[56:57], v[56:57], v[104:105]
    v_pk_add_f32 v[58:59], v[58:59], v[106:107]
    v_pk_add_f32 v[60:61], v[60:61], v[108:109]
    v_pk_add_f32 v[62:63], v[62:63], v[110:111]
    v_cvt_pk_bf16_f32 v64, v56, v57
    v_cvt_pk_bf16_f32 v65, v58, v59
    v_cvt_pk_bf16_f32 v66, v60, v61
    v_cvt_pk_bf16_f32 v67, v62, v63
    v_min_u32 v64, -2, v64
    v_min_u32 v65, -2, v65
    v_min_u32 v66, -2, v66
    v_min_u32 v67, -2, v67
    buffer_store_dwordx2 v[64:65], v5, s[8:11], s26 offen sc1
    buffer_store_dwordx2 v[66:67], v5, s[8:11], s27 offen sc1
    s_waitcnt vmcnt(0)
    s_barrier
    v_mov_b32 v4, 131072
    v_lshrrev_b32 v7, 5, v1
    s_cmp_lt_u32 s2, 14
    s_cbranch_scc1 L_m_prod
    s_and_b32 s30, s2, 7
    s_lshr_b32 s31, s2, 3
    s_lshl_b32 s30, s30, 2
    s_lshr_b32 s12, s31, 3
    s_add_u32 s30, s30, s12
    s_and_b32 s31, s31, 7
    s_bfe_u32 s12, s3, 0x10001
    s_lshl_b32 s32, s31, 1
    s_add_u32 s32, s32, s12
    s_and_b32 s12, s3, 1
    s_lshl_b32 s33, s30, 1
    s_add_u32 s33, s33, s12
    s_xor_b32 s12, s32, 1
    s_mul_i32 s34, s32, 88064
    s_mul_i32 s35, s12, 88064
    s_xor_b32 s12, s33, 1
    s_mul_i32 s36, s33, 88064
    s_mul_i32 s37, s12, 88064
    s_lshl_b32 s12, s3, 10
    s_add_u32 s13, s12, 11534336
    s_add_u32 s34, s34, s13
    s_add_u32 s35, s35, s13
    s_add_u32 s13, s12, s90
    s_add_u32 s36, s36, s13
    s_add_u32 s37, s37, s13
    s_cmp_ge_u32 s3, 6
    s_cselect_b32 s22, 0, s10
    s_mov_b32 s4, s52
    s_mov_b32 s5, s53
    s_mov_b32 s6, s54
    s_mul_i32 s12, s4, 98304
    s_lshl_b32 s13, s3, 10
    s_add_u32 s12, s12, s13
    s_add_u32 s12, s12, s87
    s_mul_i32 s25, s3, 3072
    v_add_u32 v5, s25, v3
    s_cmp_eq_u32 s4, 21
    s_cselect_b32 s50, 0, s10
    s_mov_b32 s13, 0
    v_lshlrev_b32 v13, 2, v1
    s_lshl_b32 s14, s6, 11
    s_add_u32 s14, s14, 30408704
    buffer_load_dword v152, v13, s[8:11], s14 offen offset:0 sc1
    buffer_load_dword v153, v13, s[8:11], s14 offen offset:256 sc1
    buffer_load_dword v154, v13, s[8:11], s14 offen offset:512 sc1
    buffer_load_dword v155, v13, s[8:11], s14 offen offset:768 sc1
    buffer_load_dword v156, v13, s[8:11], s14 offen offset:1024 sc1
    buffer_load_dword v157, v13, s[8:11], s14 offen offset:1280 sc1
    buffer_load_dword v158, v13, s[8:11], s14 offen offset:1536 sc1
    buffer_load_dword v159, v13, s[8:11], s14 offen offset:1792 sc1
    v_and_b32 v6, 15, v1
    v_lshrrev_b32 v12, 2, v6
    v_lshl_add_u32 v12, v7, 3, v12
    v_lshlrev_b32 v12, 6, v12
    v_and_b32 v8, 3, v6
    v_lshl_add_u32 v12, v8, 3, v12
    v_and_b32 v8, 16, v1
    v_lshl_add_u32 v12, v8, 1, v12
    v_add_u32 v14, 49152, v12
    s_lshl_b32 s15, s3, 2
    v_add_u32 v2, s15, v4
    s_mov_b32 s28, 0
    s_mov_b32 s29, 0
    v_mov_b32 v16, 0
    v_mov_b32 v17, 0
    v_mov_b32 v18, 0
    v_mov_b32 v19, 0
    v_mov_b32 v20, 0
    v_mov_b32 v21, 0
    v_mov_b32 v22, 0
    v_mov_b32 v23, 0
    v_mov_b32 v24, 0
    v_mov_b32 v25, 0
    v_mov_b32 v26, 0
    v_mov_b32 v27, 0
    v_mov_b32 v28, 0
    v_mov_b32 v29, 0
    v_mov_b32 v30, 0
    v_mov_b32 v31, 0
    v_mov_b32 v32, 0
    v_mov_b32 v33, 0
    v_mov_b32 v34, 0
    v_mov_b32 v35, 0
    v_mov_b32 v36, 0
    v_mov_b32 v37, 0
    v_mov_b32 v38, 0
    v_mov_b32 v39, 0
    v_mov_b32 v40, 0
    v_mov_b32 v41, 0
    v_mov_b32 v42, 0
    v_mov_b32 v43, 0
    v_mov_b32 v44, 0
    v_mov_b32 v45, 0
    v_mov_b32 v46, 0
    v_mov_b32 v47, 0
    v_mov_b32 v48, 0
    v_mov_b32 v49, 0
    v_mov_b32 v50, 0
    v_mov_b32 v51, 0
    v_mov_b32 v52, 0
    v_mov_b32 v53, 0
    v_mov_b32 v54, 0
    v_mov_b32 v55, 0
    v_mov_b32 v56, 0
    v_mov_b32 v57, 0
    v_mov_b32 v58, 0
    v_mov_b32 v59, 0
    v_mov_b32 v60, 0
    v_mov_b32 v61, 0
    v_mov_b32 v62, 0
    v_mov_b32 v63, 0
    s_waitcnt vmcnt(0)
    v_add_f32 v152, v152, v153
    v_add_f32 v154, v154, v155
    v_add_f32 v156, v156, v157
    v_add_f32 v158, v158, v159
    v_add_f32 v152, v152, v154
    v_add_f32 v156, v156, v158
    v_add_f32 v166, v152, v156
    v_mov_b32 v167, 0
    s_add_u32 m0, s25, 0
    s_add_u32 s14, s12, 0
    buffer_load_dwordx4 v3, s[8:11], s14 offen sc1 lds
    s_add_u32 m0, s25, 1024
    s_add_u32 s14, s12, 32768
    buffer_load_dwordx4 v3, s[48:51], s14 offen sc1 lds
    s_add_u32 m0, s25, 2048
    s_add_u32 s14, s12, 65536
    buffer_load_dwordx4 v3, s[48:51], s14 offen sc1 lds
    s_add_u32 m0, s25, 24576
    s_add_u32 s14, s12, 8192
    buffer_load_dwordx4 v3, s[8:11], s14 offen sc1 lds
    s_add_u32 m0, s25, 25600
    s_add_u32 s14, s12, 40960
    buffer_load_dwordx4 v3, s[48:51], s14 offen sc1 lds
    s_add_u32 m0, s25, 26624
    s_add_u32 s14, s12, 73728
    buffer_load_dwordx4 v3, s[48:51], s14 offen sc1 lds
    s_waitcnt vmcnt(3)
L_vf0:
    ds_read_b128 v[144:147], v5 offset:0
    ds_read_b128 v[148:151], v5 offset:1024
    ds_read_b128 v[152:155], v5 offset:2048
    v_mov_b32 v6, 1
    s_waitcnt lgkmcnt(0)
    v_max3_u32 v144, v144, v145, v146
    v_max3_u32 v147, v147, v148, v149
    v_max3_u32 v150, v150, v151, v152
    v_max3_u32 v153, v153, v154, v155
    v_max3_u32 v144, v144, v147, v150
    v_max_u32 v144, v144, v153
    v_cmp_eq_u32 vcc, -1, v144
    s_cmp_eq_u64 vcc, 0
    s_cbranch_scc1 L_vo0
    s_add_u32 s13, s13, 1
    s_cmp_ge_u32 s13, 200000
    s_cbranch_scc1 L_vo0
    s_sleep 3
    s_add_u32 m0, s25, 0
    s_add_u32 s14, s12, 0
    buffer_load_dwordx4 v3, s[8:11], s14 offen sc1 lds
    s_add_u32 m0, s25, 1024
    s_add_u32 s14, s12, 32768
    buffer_load_dwordx4 v3, s[48:51], s14 offen sc1 lds
    s_add_u32 m0, s25, 2048
    s_add_u32 s14, s12, 65536
    buffer_load_dwordx4 v3, s[48:51], s14 offen sc1 lds
    s_waitcnt vmcnt(0)
    s_branch L_vf0
L_vo0:
    ds_write_b32 v2, v6
    s_add_u32 m0, s25, 49152
    s_add_u32 s14, s12, 16384
    buffer_load_dwordx4 v3, s[8:11], s14 offen sc1 lds
    s_add_u32 m0, s25, 50176
    s_add_u32 s14, s12, 49152
    buffer_load_dwordx4 v3, s[48:51], s14 offen sc1 lds
    s_add_u32 m0, s25, 51200
    s_add_u32 s14, s12, 81920
    buffer_load_dwordx4 v3, s[48:51], s14 offen sc1 lds
    s_add_u32 m0, s25, 73728
    s_add_u32 s14, s12, 24576
    buffer_load_dwordx4 v3, s[8:11], s14 offen sc1 lds
    s_add_u32 m0, s25, 74752
    s_add_u32 s14, s12, 57344
    buffer_load_dwordx4 v3, s[48:51], s14 offen sc1 lds
    s_add_u32 m0, s25, 75776
    s_add_u32 s14, s12, 90112
    buffer_load_dwordx4 v3, s[48:51], s14 offen sc1 lds
    s_cmp_ge_u32 s28, 1
    s_cbranch_scc1 L_m_pda
    L_m_pla:
    ds_read_b128 v[8:11], v4 offset:0
    s_waitcnt lgkmcnt(0)
    v_min_u32 v8, v8, v9
    v_min3_u32 v8, v8, v10, v11
    s_nop 0
    v_readfirstlane_b32 s28, v8
    s_cmp_ge_u32 s28, 1
    s_cbranch_scc0 L_m_pla
    L_m_pda:
    ds_read_b64_tr_b16 v[64:65], v12 offset:0
    ds_read_b64_tr_b16 v[66:67], v12 offset:256
    ds_read_b64_tr_b16 v[68:69], v12 offset:1024
    ds_read_b64_tr_b16 v[70:71], v12 offset:1280
    ds_read_b64_tr_b16 v[72:73], v12 offset:2048
    ds_read_b64_tr_b16 v[74:75], v12 offset:2304
    ds_read_b64_tr_b16 v[76:77], v12 offset:3072
    ds_read_b64_tr_b16 v[78:79], v12 offset:3328
    ds_read_b64_tr_b16 v[80:81], v12 offset:4096
    ds_read_b64_tr_b16 v[82:83], v12 offset:4352
    ds_read_b64_tr_b16 v[84:85], v12 offset:5120
    ds_read_b64_tr_b16 v[86:87], v12 offset:5376
    s_waitcnt lgkmcnt(10)
    v_mfma_f32_32x32x16_bf16 v[16:31], v[168:171], v[64:67], v[16:31]
    ds_read_b64_tr_b16 v[88:89], v12 offset:6144
    ds_read_b64_tr_b16 v[90:91], v12 offset:6400
    s_waitcnt lgkmcnt(10)
    v_mfma_f32_32x32x16_bf16 v[32:47], v[168:171], v[68:71], v[32:47]
    ds_read_b64_tr_b16 v[92:93], v12 offset:7168
    ds_read_b64_tr_b16 v[94:95], v12 offset:7424
    s_waitcnt lgkmcnt(10)
    v_mfma_f32_32x32x16_bf16 v[48:63], v[168:171], v[72:75], v[48:63]
    ds_read_b64_tr_b16 v[96:97], v12 offset:8192
    ds_read_b64_tr_b16 v[98:99], v12 offset:8448
    s_waitcnt lgkmcnt(10)
    v_mfma_f32_32x32x16_bf16 v[16:31], v[172:175], v[76:79], v[16:31]
    ds_read_b64_tr_b16 v[100:101], v12 offset:9216
    ds_read_b64_tr_b16 v[102:103], v12 offset:9472
    s_waitcnt lgkmcnt(10)
    v_mfma_f32_32x32x16_bf16 v[32:47], v[172:175], v[80:83], v[32:47]
    ds_read_b64_tr_b16 v[104:105], v12 offset:10240
    ds_read_b64_tr_b16 v[106:107], v12 offset:10496
    s_waitcnt lgkmcnt(10)
    v_mfma_f32_32x32x16_bf16 v[48:63], v[172:175], v[84:87], v[48:63]
    ds_read_b64_tr_b16 v[108:109], v12 offset:11264
    ds_read_b64_tr_b16 v[110:111], v12 offset:11520
    s_cmp_ge_u32 s29, 1
    s_cbranch_scc1 L_m_pdm2
    L_m_plm2:
    ds_read_b128 v[8:11], v4 offset:16
    s_waitcnt lgkmcnt(0)
    v_min_u32 v8, v8, v9
    v_min3_u32 v8, v8, v10, v11
    s_nop 0
    v_readfirstlane_b32 s29, v8
    s_cmp_ge_u32 s29, 1
    s_cbranch_scc0 L_m_plm2
    L_m_pdm2:
    s_waitcnt vmcnt(6)
L_vf1:
    ds_read_b128 v[144:147], v5 offset:24576
    ds_read_b128 v[148:151], v5 offset:25600
    ds_read_b128 v[152:155], v5 offset:26624
    v_mov_b32 v6, 2
    s_waitcnt lgkmcnt(0)
    v_max3_u32 v144, v144, v145, v146
    v_max3_u32 v147, v147, v148, v149
    v_max3_u32 v150, v150, v151, v152
    v_max3_u32 v153, v153, v154, v155
    v_max3_u32 v144, v144, v147, v150
    v_max_u32 v144, v144, v153
    v_cmp_eq_u32 vcc, -1, v144
    s_cmp_eq_u64 vcc, 0
    s_cbranch_scc1 L_vo1
    s_add_u32 s13, s13, 1
    s_cmp_ge_u32 s13, 200000
    s_cbranch_scc1 L_vo1
    s_sleep 3
    s_add_u32 m0, s25, 24576
    s_add_u32 s14, s12, 8192
    buffer_load_dwordx4 v3, s[8:11], s14 offen sc1 lds
    s_add_u32 m0, s25, 25600
    s_add_u32 s14, s12, 40960
    buffer_load_dwordx4 v3, s[48:51], s14 offen sc1 lds
    s_add_u32 m0, s25, 26624
    s_add_u32 s14, s12, 73728
    buffer_load_dwordx4 v3, s[48:51], s14 offen sc1 lds
    s_waitcnt vmcnt(0)
    s_branch L_vf1
L_vo1:
    ds_write_b32 v2, v6
    v_add_u32 v5, 49152, v5
    v_mfma_f32_32x32x16_bf16 v[16:31], v[176:179], v[88:91], v[16:31]
    ds_read_b64_tr_b16 v[64:65], v12 offset:12288
    ds_read_b64_tr_b16 v[66:67], v12 offset:12544
    v_mfma_f32_32x32x16_bf16 v[32:47], v[176:179], v[92:95], v[32:47]
    ds_read_b64_tr_b16 v[68:69], v12 offset:13312
    ds_read_b64_tr_b16 v[70:71], v12 offset:13568
    v_mfma_f32_32x32x16_bf16 v[48:63], v[176:179], v[96:99], v[48:63]
    ds_read_b64_tr_b16 v[72:73], v12 offset:14336
    ds_read_b64_tr_b16 v[74:75], v12 offset:14592
    v_mfma_f32_32x32x16_bf16 v[16:31], v[180:183], v[100:103], v[16:31]
    ds_read_b64_tr_b16 v[76:77], v12 offset:15360
    ds_read_b64_tr_b16 v[78:79], v12 offset:15616
    v_mfma_f32_32x32x16_bf16 v[32:47], v[180:183], v[104:107], v[32:47]
    ds_read_b64_tr_b16 v[80:81], v12 offset:16384
    ds_read_b64_tr_b16 v[82:83], v12 offset:16640
    v_mfma_f32_32x32x16_bf16 v[48:63], v[180:183], v[108:111], v[48:63]
    ds_read_b64_tr_b16 v[84:85], v12 offset:17408
    ds_read_b64_tr_b16 v[86:87], v12 offset:17664
    s_waitcnt lgkmcnt(10)
    v_mfma_f32_32x32x16_bf16 v[16:31], v[184:187], v[64:67], v[16:31]
    ds_read_b64_tr_b16 v[88:89], v12 offset:18432
    ds_read_b64_tr_b16 v[90:91], v12 offset:18688
    s_waitcnt lgkmcnt(10)
    v_mfma_f32_32x32x16_bf16 v[32:47], v[184:187], v[68:71], v[32:47]
    ds_read_b64_tr_b16 v[92:93], v12 offset:19456
    ds_read_b64_tr_b16 v[94:95], v12 offset:19712
    s_waitcnt lgkmcnt(10)
    v_mfma_f32_32x32x16_bf16 v[48:63], v[184:187], v[72:75], v[48:63]
    ds_read_b64_tr_b16 v[96:97], v12 offset:20480
    ds_read_b64_tr_b16 v[98:99], v12 offset:20736
    s_waitcnt vmcnt(3)
L_vf2:
    ds_read_b128 v[144:147], v5 offset:0
    ds_read_b128 v[148:151], v5 offset:1024
    ds_read_b128 v[152:155], v5 offset:2048
    v_mov_b32 v6, 3
    s_waitcnt lgkmcnt(0)
    v_max3_u32 v144, v144, v145, v146
    v_max3_u32 v147, v147, v148, v149
    v_max3_u32 v150, v150, v151, v152
    v_max3_u32 v153, v153, v154, v155
    v_max3_u32 v144, v144, v147, v150
    v_max_u32 v144, v144, v153
    v_cmp_eq_u32 vcc, -1, v144
    s_cmp_eq_u64 vcc, 0
    s_cbranch_scc1 L_vo2
    s_add_u32 s13, s13, 1
    s_cmp_ge_u32 s13, 200000
    s_cbranch_scc1 L_vo2
    s_sleep 3
    s_add_u32 m0, s25, 49152
    s_add_u32 s14, s12, 16384
    buffer_load_dwordx4 v3, s[8:11], s14 offen sc1 lds
    s_add_u32 m0, s25, 50176
    s_add_u32 s14, s12, 49152
    buffer_load_dwordx4 v3, s[48:51], s14 offen sc1 lds
    s_add_u32 m0, s25, 51200
    s_add_u32 s14, s12, 81920
    buffer_load_dwordx4 v3, s[48:51], s14 offen sc1 lds
    s_waitcnt vmcnt(0)
    s_branch L_vf2
L_vo2:
    ds_write_b32 v2, v6
    v_mfma_f32_32x32x16_bf16 v[16:31], v[188:191], v[76:79], v[16:31]
    ds_read_b64_tr_b16 v[100:101], v12 offset:21504
    ds_read_b64_tr_b16 v[102:103], v12 offset:21760
    v_mfma_f32_32x32x16_bf16 v[32:47], v[188:191], v[80:83], v[32:47]
    ds_read_b64_tr_b16 v[104:105], v12 offset:22528
    ds_read_b64_tr_b16 v[106:107], v12 offset:22784
    v_mfma_f32_32x32x16_bf16 v[48:63], v[188:191], v[84:87], v[48:63]
    ds_read_b64_tr_b16 v[108:109], v12 offset:23552
    ds_read_b64_tr_b16 v[110:111], v12 offset:23808
    s_cmp_ge_u32 s28, 2
    s_cbranch_scc1 L_m_pdm6
    L_m_plm6:
    ds_read_b128 v[8:11], v4 offset:0
    s_waitcnt lgkmcnt(0)
    v_min_u32 v8, v8, v9
    v_min3_u32 v8, v8, v10, v11
    s_nop 0
    v_readfirstlane_b32 s28, v8
    s_cmp_ge_u32 s28, 2
    s_cbranch_scc0 L_m_plm6
    L_m_pdm6:
    v_mfma_f32_32x32x16_bf16 v[16:31], v[192:195], v[88:91], v[16:31]
    ds_read_b64_tr_b16 v[64:65], v12 offset:24576
    ds_read_b64_tr_b16 v[66:67], v12 offset:24832
    v_mfma_f32_32x32x16_bf16 v[32:47], v[192:195], v[92:95], v[32:47]
    ds_read_b64_tr_b16 v[68:69], v12 offset:25600
    ds_read_b64_tr_b16 v[70:71], v12 offset:25856
    v_mfma_f32_32x32x16_bf16 v[48:63], v[192:195], v[96:99], v[48:63]
    ds_read_b64_tr_b16 v[72:73], v12 offset:26624
    ds_read_b64_tr_b16 v[74:75], v12 offset:26880
    s_waitcnt lgkmcnt(10)
    v_mfma_f32_32x32x16_bf16 v[16:31], v[196:199], v[100:103], v[16:31]
    ds_read_b64_tr_b16 v[76:77], v12 offset:27648
    ds_read_b64_tr_b16 v[78:79], v12 offset:27904
    s_waitcnt lgkmcnt(10)
    v_mfma_f32_32x32x16_bf16 v[32:47], v[196:199], v[104:107], v[32:47]
    ds_read_b64_tr_b16 v[80:81], v12 offset:28672
    ds_read_b64_tr_b16 v[82:83], v12 offset:28928
    s_waitcnt lgkmcnt(10)
    v_mfma_f32_32x32x16_bf16 v[48:63], v[196:199], v[108:111], v[48:63]
    ds_read_b64_tr_b16 v[84:85], v12 offset:29696
    ds_read_b64_tr_b16 v[86:87], v12 offset:29952
    s_waitcnt vmcnt(0)
L_vf3:
    ds_read_b128 v[144:147], v5 offset:24576
    ds_read_b128 v[148:151], v5 offset:25600
    ds_read_b128 v[152:155], v5 offset:26624
    v_mov_b32 v6, 4
    s_waitcnt lgkmcnt(0)
    v_max3_u32 v144, v144, v145, v146
    v_max3_u32 v147, v147, v148, v149
    v_max3_u32 v150, v150, v151, v152
    v_max3_u32 v153, v153, v154, v155
    v_max3_u32 v144, v144, v147, v150
    v_max_u32 v144, v144, v153
    v_cmp_eq_u32 vcc, -1, v144
    s_cmp_eq_u64 vcc, 0
    s_cbranch_scc1 L_vo3
    s_add_u32 s13, s13, 1
    s_cmp_ge_u32 s13, 200000
    s_cbranch_scc1 L_vo3
    s_sleep 3
    s_add_u32 m0, s25, 73728
    s_add_u32 s14, s12, 24576
    buffer_load_dwordx4 v3, s[8:11], s14 offen sc1 lds
    s_add_u32 m0, s25, 74752
    s_add_u32 s14, s12, 57344
    buffer_load_dwordx4 v3, s[48:51], s14 offen sc1 lds
    s_add_u32 m0, s25, 75776
    s_add_u32 s14, s12, 90112
    buffer_load_dwordx4 v3, s[48:51], s14 offen sc1 lds
    s_waitcnt vmcnt(0)
    s_branch L_vf3
L_vo3:
    ds_write_b32 v2, v6
    v_mfma_f32_32x32x16_bf16 v[16:31], v[200:203], v[64:67], v[16:31]
    ds_read_b64_tr_b16 v[88:89], v12 offset:30720
    ds_read_b64_tr_b16 v[90:91], v12 offset:30976
    v_mfma_f32_32x32x16_bf16 v[32:47], v[200:203], v[68:71], v[32:47]
    ds_read_b64_tr_b16 v[92:93], v12 offset:31744
    ds_read_b64_tr_b16 v[94:95], v12 offset:32000
    v_mfma_f32_32x32x16_bf16 v[48:63], v[200:203], v[72:75], v[48:63]
    ds_read_b64_tr_b16 v[96:97], v12 offset:32768
    ds_read_b64_tr_b16 v[98:99], v12 offset:33024
    s_add_u32 s14, s55, 20480
    buffer_load_dwordx4 v[112:115], v3, s[8:11], s14 offen offset:2048 sc1
    s_add_u32 s14, s34, 8192
    buffer_load_dwordx4 v[176:179], v3, s[8:11], s14 offen sc1
    v_mfma_f32_32x32x16_bf16 v[16:31], v[204:207], v[76:79], v[16:31]
    ds_read_b64_tr_b16 v[100:101], v12 offset:33792
    ds_read_b64_tr_b16 v[102:103], v12 offset:34048
    v_mfma_f32_32x32x16_bf16 v[32:47], v[204:207], v[80:83], v[32:47]
    ds_read_b64_tr_b16 v[104:105], v12 offset:34816
    ds_read_b64_tr_b16 v[106:107], v12 offset:35072
    v_mfma_f32_32x32x16_bf16 v[48:63], v[204:207], v[84:87], v[48:63]
    ds_read_b64_tr_b16 v[108:109], v12 offset:35840
    ds_read_b64_tr_b16 v[110:111], v12 offset:36096
    s_add_u32 s14, s55, 20480
    buffer_load_dwordx4 v[116:119], v3, s[8:11], s14 offen offset:3072 sc1
    s_add_u32 s14, s35, 8192
    buffer_load_dwordx4 v[180:183], v3, s[8:11], s14 offen sc1
    s_cmp_ge_u32 s29, 2
    s_cbranch_scc1 L_m_pdm10
    L_m_plm10:
    ds_read_b128 v[8:11], v4 offset:16
    s_waitcnt lgkmcnt(0)
    v_min_u32 v8, v8, v9
    v_min3_u32 v8, v8, v10, v11
    s_nop 0
    v_readfirstlane_b32 s29, v8
    s_cmp_ge_u32 s29, 2
    s_cbranch_scc0 L_m_plm10
    L_m_pdm10:
    s_waitcnt lgkmcnt(10)
    v_mfma_f32_32x32x16_bf16 v[16:31], v[208:211], v[88:91], v[16:31]
    ds_read_b64_tr_b16 v[64:65], v12 offset:36864
    ds_read_b64_tr_b16 v[66:67], v12 offset:37120
    s_waitcnt lgkmcnt(10)
    v_mfma_f32_32x32x16_bf16 v[32:47], v[208:211], v[92:95], v[32:47]
    ds_read_b64_tr_b16 v[68:69], v12 offset:37888
    ds_read_b64_tr_b16 v[70:71], v12 offset:38144
    s_waitcnt lgkmcnt(10)
    v_mfma_f32_32x32x16_bf16 v[48:63], v[208:211], v[96:99], v[48:63]
    ds_read_b64_tr_b16 v[72:73], v12 offset:38912
    ds_read_b64_tr_b16 v[74:75], v12 offset:39168
    s_add_u32 s14, s55, 24576
    buffer_load_dwordx4 v[120:123], v3, s[8:11], s14 offen offset:0 sc1
    s_add_u32 s14, s34, 16384
    buffer_load_dwordx4 v[184:187], v3, s[8:11], s14 offen sc1
    s_waitcnt lgkmcnt(10)
    v_mfma_f32_32x32x16_bf16 v[16:31], v[212:215], v[100:103], v[16:31]
    ds_read_b64_tr_b16 v[76:77], v12 offset:39936
    ds_read_b64_tr_b16 v[78:79], v12 offset:40192
    s_waitcnt lgkmcnt(10)
    v_mfma_f32_32x32x16_bf16 v[32:47], v[212:215], v[104:107], v[32:47]
    ds_read_b64_tr_b16 v[80:81], v12 offset:40960
    ds_read_b64_tr_b16 v[82:83], v12 offset:41216
    s_waitcnt lgkmcnt(10)
    v_mfma_f32_32x32x16_bf16 v[48:63], v[212:215], v[108:111], v[48:63]
    ds_read_b64_tr_b16 v[84:85], v12 offset:41984
    ds_read_b64_tr_b16 v[86:87], v12 offset:42240
    s_add_u32 s14, s55, 24576
    buffer_load_dwordx4 v[124:127], v3, s[8:11], s14 offen offset:1024 sc1
    s_add_u32 s14, s35, 16384
    buffer_load_dwordx4 v[188:191], v3, s[8:11], s14 offen sc1
    s_waitcnt lgkmcnt(10)
    v_mfma_f32_32x32x16_bf16 v[16:31], v[216:219], v[64:67], v[16:31]
    ds_read_b64_tr_b16 v[88:89], v12 offset:43008
    ds_read_b64_tr_b16 v[90:91], v12 offset:43264
    s_waitcnt lgkmcnt(10)
    v_mfma_f32_32x32x16_bf16 v[32:47], v[216:219], v[68:71], v[32:47]
    ds_read_b64_tr_b16 v[92:93], v12 offset:44032
    ds_read_b64_tr_b16 v[94:95], v12 offset:44288
    s_waitcnt lgkmcnt(10)
    v_mfma_f32_32x32x16_bf16 v[48:63], v[216:219], v[72:75], v[48:63]
    ds_read_b64_tr_b16 v[96:97], v12 offset:45056
    ds_read_b64_tr_b16 v[98:99], v12 offset:45312
    s_add_u32 s14, s55, 24576
    buffer_load_dwordx4 v[128:131], v3, s[8:11], s14 offen offset:2048 sc1
    s_add_u32 s14, s55, 28672
    buffer_load_dwordx4 v[168:171], v3, s[8:11], s14 offen offset:2048 sc1
    s_add_u32 s14, s34, 24576
    buffer_load_dwordx4 v[192:195], v3, s[8:11], s14 offen sc1
    s_waitcnt lgkmcnt(10)
    v_mfma_f32_32x32x16_bf16 v[16:31], v[220:223], v[76:79], v[16:31]
    ds_read_b64_tr_b16 v[100:101], v12 offset:46080
    ds_read_b64_tr_b16 v[102:103], v12 offset:46336
    s_waitcnt lgkmcnt(10)
    v_mfma_f32_32x32x16_bf16 v[32:47], v[220:223], v[80:83], v[32:47]
    ds_read_b64_tr_b16 v[104:105], v12 offset:47104
    ds_read_b64_tr_b16 v[106:107], v12 offset:47360
    s_waitcnt lgkmcnt(10)
    v_mfma_f32_32x32x16_bf16 v[48:63], v[220:223], v[84:87], v[48:63]
    ds_read_b64_tr_b16 v[108:109], v12 offset:48128
    ds_read_b64_tr_b16 v[110:111], v12 offset:48384
    s_add_u32 s14, s55, 24576
    buffer_load_dwordx4 v[132:135], v3, s[8:11], s14 offen offset:3072 sc1
    s_add_u32 s14, s55, 28672
    buffer_load_dwordx4 v[172:175], v3, s[8:11], s14 offen offset:3072 sc1
    s_add_u32 s14, s35, 24576
    buffer_load_dwordx4 v[196:199], v3, s[8:11], s14 offen sc1
    s_cmp_ge_u32 s28, 3
    s_cbranch_scc1 L_m_pdm14
    L_m_plm14:
    ds_read_b128 v[8:11], v4 offset:0
    s_waitcnt lgkmcnt(0)
    v_min_u32 v8, v8, v9
    v_min3_u32 v8, v8, v10, v11
    s_nop 0
    v_readfirstlane_b32 s28, v8
    s_cmp_ge_u32 s28, 3
    s_cbranch_scc0 L_m_plm14
    L_m_pdm14:
    s_waitcnt lgkmcnt(10)
    v_mfma_f32_32x32x16_bf16 v[16:31], v[224:227], v[88:91], v[16:31]
    ds_read_b64_tr_b16 v[64:65], v14 offset:0
    ds_read_b64_tr_b16 v[66:67], v14 offset:256
    s_waitcnt lgkmcnt(10)
    v_mfma_f32_32x32x16_bf16 v[32:47], v[224:227], v[92:95], v[32:47]
    ds_read_b64_tr_b16 v[68:69], v14 offset:1024
    ds_read_b64_tr_b16 v[70:71], v14 offset:1280
    s_waitcnt lgkmcnt(10)
    v_mfma_f32_32x32x16_bf16 v[48:63], v[224:227], v[96:99], v[48:63]
    ds_read_b64_tr_b16 v[72:73], v14 offset:2048
    ds_read_b64_tr_b16 v[74:75], v14 offset:2304
    s_add_u32 s14, s55, 28672
    buffer_load_dwordx4 v[136:139], v3, s[8:11], s14 offen offset:0 sc1
    s_add_u32 s14, s34, 32768
    buffer_load_dwordx4 v[200:203], v3, s[8:11], s14 offen sc1
    s_waitcnt lgkmcnt(10)
    v_mfma_f32_32x32x16_bf16 v[16:31], v[228:231], v[100:103], v[16:31]
    ds_read_b64_tr_b16 v[76:77], v14 offset:3072
    ds_read_b64_tr_b16 v[78:79], v14 offset:3328
    s_waitcnt lgkmcnt(10)
    v_mfma_f32_32x32x16_bf16 v[32:47], v[228:231], v[104:107], v[32:47]
    ds_read_b64_tr_b16 v[80:81], v14 offset:4096
    ds_read_b64_tr_b16 v[82:83], v14 offset:4352
    s_waitcnt lgkmcnt(10)
    v_mfma_f32_32x32x16_bf16 v[48:63], v[228:231], v[108:111], v[48:63]
    ds_read_b64_tr_b16 v[84:85], v14 offset:5120
    ds_read_b64_tr_b16 v[86:87], v14 offset:5376
    s_add_u32 s14, s55, 28672
    buffer_load_dwordx4 v[140:143], v3, s[8:11], s14 offen offset:1024 sc1
    s_add_u32 s14, s35, 32768
    buffer_load_dwordx4 v[204:207], v3, s[8:11], s14 offen sc1
    s_waitcnt lgkmcnt(10)
    v_mfma_f32_32x32x16_bf16 v[16:31], v[232:235], v[64:67], v[16:31]
    ds_read_b64_tr_b16 v[88:89], v14 offset:6144
    ds_read_b64_tr_b16 v[90:91], v14 offset:6400
    s_waitcnt lgkmcnt(10)
    v_mfma_f32_32x32x16_bf16 v[32:47], v[232:235], v[68:71], v[32:47]
    ds_read_b64_tr_b16 v[92:93], v14 offset:7168
    ds_read_b64_tr_b16 v[94:95], v14 offset:7424
    s_waitcnt lgkmcnt(10)
    v_mfma_f32_32x32x16_bf16 v[48:63], v[232:235], v[72:75], v[48:63]
    ds_read_b64_tr_b16 v[96:97], v14 offset:8192
    ds_read_b64_tr_b16 v[98:99], v14 offset:8448
    s_add_u32 s14, s34, 40960
    buffer_load_dwordx4 v[208:211], v3, s[8:11], s14 offen sc1
    s_waitcnt lgkmcnt(10)
    v_mfma_f32_32x32x16_bf16 v[16:31], v[236:239], v[76:79], v[16:31]
    ds_read_b64_tr_b16 v[100:101], v14 offset:9216
    ds_read_b64_tr_b16 v[102:103], v14 offset:9472
    s_waitcnt lgkmcnt(10)
    v_mfma_f32_32x32x16_bf16 v[32:47], v[236:239], v[80:83], v[32:47]
    ds_read_b64_tr_b16 v[104:105], v14 offset:10240
    ds_read_b64_tr_b16 v[106:107], v14 offset:10496
    s_waitcnt lgkmcnt(10)
    v_mfma_f32_32x32x16_bf16 v[48:63], v[236:239], v[84:87], v[48:63]
    ds_read_b64_tr_b16 v[108:109], v14 offset:11264
    ds_read_b64_tr_b16 v[110:111], v14 offset:11520
    s_add_u32 s14, s35, 40960
    buffer_load_dwordx4 v[212:215], v3, s[8:11], s14 offen sc1
    s_cmp_ge_u32 s29, 3
    s_cbranch_scc1 L_m_pdm18
    L_m_plm18:
    ds_read_b128 v[8:11], v4 offset:16
    s_waitcnt lgkmcnt(0)
    v_min_u32 v8, v8, v9
    v_min3_u32 v8, v8, v10, v11
    s_nop 0
    v_readfirstlane_b32 s29, v8
    s_cmp_ge_u32 s29, 3
    s_cbranch_scc0 L_m_plm18
    L_m_pdm18:
    s_waitcnt lgkmcnt(10)
    v_mfma_f32_32x32x16_bf16 v[16:31], v[240:243], v[88:91], v[16:31]
    ds_read_b64_tr_b16 v[64:65], v14 offset:12288
    ds_read_b64_tr_b16 v[66:67], v14 offset:12544
    s_waitcnt lgkmcnt(10)
    v_mfma_f32_32x32x16_bf16 v[32:47], v[240:243], v[92:95], v[32:47]
    ds_read_b64_tr_b16 v[68:69], v14 offset:13312
    ds_read_b64_tr_b16 v[70:71], v14 offset:13568
    s_waitcnt lgkmcnt(10)
    v_mfma_f32_32x32x16_bf16 v[48:63], v[240:243], v[96:99], v[48:63]
    ds_read_b64_tr_b16 v[72:73], v14 offset:14336
    ds_read_b64_tr_b16 v[74:75], v14 offset:14592
    s_add_u32 s14, s34, 49152
    buffer_load_dwordx4 v[216:219], v3, s[8:11], s14 offen sc1
    s_waitcnt lgkmcnt(10)
    v_mfma_f32_32x32x16_bf16 v[16:31], v[244:247], v[100:103], v[16:31]
    ds_read_b64_tr_b16 v[76:77], v14 offset:15360
    ds_read_b64_tr_b16 v[78:79], v14 offset:15616
    s_waitcnt lgkmcnt(10)
    v_mfma_f32_32x32x16_bf16 v[32:47], v[244:247], v[104:107], v[32:47]
    ds_read_b64_tr_b16 v[80:81], v14 offset:16384
    ds_read_b64_tr_b16 v[82:83], v14 offset:16640
    s_waitcnt lgkmcnt(10)
    v_mfma_f32_32x32x16_bf16 v[48:63], v[244:247], v[108:111], v[48:63]
    ds_read_b64_tr_b16 v[84:85], v14 offset:17408
    ds_read_b64_tr_b16 v[86:87], v14 offset:17664
    s_add_u32 s14, s35, 49152
    buffer_load_dwordx4 v[220:223], v3, s[8:11], s14 offen sc1
    s_waitcnt lgkmcnt(10)
    v_mfma_f32_32x32x16_bf16 v[16:31], v[248:251], v[64:67], v[16:31]
    ds_read_b64_tr_b16 v[88:89], v14 offset:18432
    ds_read_b64_tr_b16 v[90:91], v14 offset:18688
    s_waitcnt lgkmcnt(10)
    v_mfma_f32_32x32x16_bf16 v[32:47], v[248:251], v[68:71], v[32:47]
    ds_read_b64_tr_b16 v[92:93], v14 offset:19456
    ds_read_b64_tr_b16 v[94:95], v14 offset:19712
    s_waitcnt lgkmcnt(10)
    v_mfma_f32_32x32x16_bf16 v[48:63], v[248:251], v[72:75], v[48:63]
    ds_read_b64_tr_b16 v[96:97], v14 offset:20480
    ds_read_b64_tr_b16 v[98:99], v14 offset:20736
    s_add_u32 s14, s34, 57344
    buffer_load_dwordx4 v[224:227], v3, s[8:11], s14 offen sc1
    s_waitcnt lgkmcnt(10)
    v_mfma_f32_32x32x16_bf16 v[16:31], v[252:255], v[76:79], v[16:31]
    ds_read_b64_tr_b16 v[100:101], v14 offset:21504
    ds_read_b64_tr_b16 v[102:103], v14 offset:21760
    s_waitcnt lgkmcnt(10)
    v_mfma_f32_32x32x16_bf16 v[32:47], v[252:255], v[80:83], v[32:47]
    ds_read_b64_tr_b16 v[104:105], v14 offset:22528
    ds_read_b64_tr_b16 v[106:107], v14 offset:22784
    s_waitcnt lgkmcnt(10)
    v_mfma_f32_32x32x16_bf16 v[48:63], v[252:255], v[84:87], v[48:63]
    ds_read_b64_tr_b16 v[108:109], v14 offset:23552
    ds_read_b64_tr_b16 v[110:111], v14 offset:23808
    s_add_u32 s14, s35, 57344
    buffer_load_dwordx4 v[228:231], v3, s[8:11], s14 offen sc1
    s_cmp_ge_u32 s28, 4
    s_cbranch_scc1 L_m_pdm22
    L_m_plm22:
    ds_read_b128 v[8:11], v4 offset:0
    s_waitcnt lgkmcnt(0)
    v_min_u32 v8, v8, v9
    v_min3_u32 v8, v8, v10, v11
    s_nop 0
    v_readfirstlane_b32 s28, v8
    s_cmp_ge_u32 s28, 4
    s_cbranch_scc0 L_m_plm22
    L_m_pdm22:
    s_waitcnt vmcnt(23)
    s_waitcnt lgkmcnt(10)
    v_mfma_f32_32x32x16_bf16 v[16:31], v[112:115], v[88:91], v[16:31]
    ds_read_b64_tr_b16 v[64:65], v14 offset:24576
    ds_read_b64_tr_b16 v[66:67], v14 offset:24832
    s_waitcnt lgkmcnt(10)
    v_mfma_f32_32x32x16_bf16 v[32:47], v[112:115], v[92:95], v[32:47]
    ds_read_b64_tr_b16 v[68:69], v14 offset:25600
    ds_read_b64_tr_b16 v[70:71], v14 offset:25856
    s_waitcnt lgkmcnt(10)
    v_mfma_f32_32x32x16_bf16 v[48:63], v[112:115], v[96:99], v[48:63]
    ds_read_b64_tr_b16 v[72:73], v14 offset:26624
    ds_read_b64_tr_b16 v[74:75], v14 offset:26880
    s_add_u32 s14, s34, 65536
    buffer_load_dwordx4 v[232:235], v3, s[8:11], s14 offen sc1
    s_waitcnt vmcnt(22)
    s_waitcnt lgkmcnt(10)
    v_mfma_f32_32x32x16_bf16 v[16:31], v[116:119], v[100:103], v[16:31]
    ds_read_b64_tr_b16 v[76:77], v14 offset:27648
    ds_read_b64_tr_b16 v[78:79], v14 offset:27904
    s_waitcnt lgkmcnt(10)
    v_mfma_f32_32x32x16_bf16 v[32:47], v[116:119], v[104:107], v[32:47]
    ds_read_b64_tr_b16 v[80:81], v14 offset:28672
    ds_read_b64_tr_b16 v[82:83], v14 offset:28928
    s_waitcnt lgkmcnt(10)
    v_mfma_f32_32x32x16_bf16 v[48:63], v[116:119], v[108:111], v[48:63]
    ds_read_b64_tr_b16 v[84:85], v14 offset:29696
    ds_read_b64_tr_b16 v[86:87], v14 offset:29952
    s_add_u32 s14, s35, 65536
    buffer_load_dwordx4 v[236:239], v3, s[8:11], s14 offen sc1
    s_waitcnt vmcnt(21)
    s_waitcnt lgkmcnt(10)
    v_mfma_f32_32x32x16_bf16 v[16:31], v[120:123], v[64:67], v[16:31]
    ds_read_b64_tr_b16 v[88:89], v14 offset:30720
    ds_read_b64_tr_b16 v[90:91], v14 offset:30976
    s_waitcnt lgkmcnt(10)
    v_mfma_f32_32x32x16_bf16 v[32:47], v[120:123], v[68:71], v[32:47]
    ds_read_b64_tr_b16 v[92:93], v14 offset:31744
    ds_read_b64_tr_b16 v[94:95], v14 offset:32000
    s_waitcnt lgkmcnt(10)
    v_mfma_f32_32x32x16_bf16 v[48:63], v[120:123], v[72:75], v[48:63]
    ds_read_b64_tr_b16 v[96:97], v14 offset:32768
    ds_read_b64_tr_b16 v[98:99], v14 offset:33024
    s_add_u32 s14, s34, 73728
    buffer_load_dwordx4 v[240:243], v3, s[8:11], s14 offen sc1
    s_waitcnt vmcnt(20)
    s_waitcnt lgkmcnt(10)
    v_mfma_f32_32x32x16_bf16 v[16:31], v[124:127], v[76:79], v[16:31]
    ds_read_b64_tr_b16 v[100:101], v14 offset:33792
    ds_read_b64_tr_b16 v[102:103], v14 offset:34048
    s_waitcnt lgkmcnt(10)
    v_mfma_f32_32x32x16_bf16 v[32:47], v[124:127], v[80:83], v[32:47]
    ds_read_b64_tr_b16 v[104:105], v14 offset:34816
    ds_read_b64_tr_b16 v[106:107], v14 offset:35072
    s_waitcnt lgkmcnt(10)
    v_mfma_f32_32x32x16_bf16 v[48:63], v[124:127], v[84:87], v[48:63]
    ds_read_b64_tr_b16 v[108:109], v14 offset:35840
    ds_read_b64_tr_b16 v[110:111], v14 offset:36096
    s_add_u32 s14, s35, 73728
    buffer_load_dwordx4 v[244:247], v3, s[8:11], s14 offen sc1
    s_cmp_ge_u32 s29, 4
    s_cbranch_scc1 L_m_pdm26
    L_m_plm26:
    ds_read_b128 v[8:11], v4 offset:16
    s_waitcnt lgkmcnt(0)
    v_min_u32 v8, v8, v9
    v_min3_u32 v8, v8, v10, v11
    s_nop 0
    v_readfirstlane_b32 s29, v8
    s_cmp_ge_u32 s29, 4
    s_cbranch_scc0 L_m_plm26
    L_m_pdm26:
    s_waitcnt vmcnt(19)
    s_waitcnt lgkmcnt(10)
    v_mfma_f32_32x32x16_bf16 v[16:31], v[128:131], v[88:91], v[16:31]
    ds_read_b64_tr_b16 v[64:65], v14 offset:36864
    ds_read_b64_tr_b16 v[66:67], v14 offset:37120
    s_waitcnt lgkmcnt(10)
    v_mfma_f32_32x32x16_bf16 v[32:47], v[128:131], v[92:95], v[32:47]
    ds_read_b64_tr_b16 v[68:69], v14 offset:37888
    ds_read_b64_tr_b16 v[70:71], v14 offset:38144
    s_waitcnt lgkmcnt(10)
    v_mfma_f32_32x32x16_bf16 v[48:63], v[128:131], v[96:99], v[48:63]
    ds_read_b64_tr_b16 v[72:73], v14 offset:38912
    ds_read_b64_tr_b16 v[74:75], v14 offset:39168
    s_add_u32 s14, s34, 81920
    buffer_load_dwordx4 v[248:251], v3, s[20:23], s14 offen sc1
    s_waitcnt vmcnt(17)
    s_waitcnt lgkmcnt(10)
    v_mfma_f32_32x32x16_bf16 v[16:31], v[132:135], v[100:103], v[16:31]
    ds_read_b64_tr_b16 v[76:77], v14 offset:39936
    ds_read_b64_tr_b16 v[78:79], v14 offset:40192
    s_waitcnt lgkmcnt(10)
    v_mfma_f32_32x32x16_bf16 v[32:47], v[132:135], v[104:107], v[32:47]
    ds_read_b64_tr_b16 v[80:81], v14 offset:40960
    ds_read_b64_tr_b16 v[82:83], v14 offset:41216
    s_waitcnt lgkmcnt(10)
    v_mfma_f32_32x32x16_bf16 v[48:63], v[132:135], v[108:111], v[48:63]
    ds_read_b64_tr_b16 v[84:85], v14 offset:41984
    ds_read_b64_tr_b16 v[86:87], v14 offset:42240
    s_add_u32 s14, s35, 81920
    buffer_load_dwordx4 v[252:255], v3, s[20:23], s14 offen sc1
    v_and_b32 v15, 31, v1
    v_lshlrev_b32 v15, 3, v15
    s_mul_i32 s15, s4, 768
    s_add_u32 s15, s15, s89
    s_cmp_eq_u32 s4, 21
    s_cselect_b32 s47, 0, 256
    s_add_u32 s48, s15, s47
    s_add_u32 s49, s48, s47
    s_mov_b32 s47, s15
    buffer_load_dwordx2 v[160:161], v15, s[8:11], s47 offen sc1
    buffer_load_dwordx2 v[162:163], v15, s[8:11], s48 offen sc1
    buffer_load_dwordx2 v[164:165], v15, s[8:11], s49 offen sc1
    s_waitcnt vmcnt(18)
    s_waitcnt lgkmcnt(10)
    v_mfma_f32_32x32x16_bf16 v[16:31], v[136:139], v[64:67], v[16:31]
    ds_read_b64_tr_b16 v[88:89], v14 offset:43008
    ds_read_b64_tr_b16 v[90:91], v14 offset:43264
    s_waitcnt lgkmcnt(10)
    v_mfma_f32_32x32x16_bf16 v[32:47], v[136:139], v[68:71], v[32:47]
    ds_read_b64_tr_b16 v[92:93], v14 offset:44032
    ds_read_b64_tr_b16 v[94:95], v14 offset:44288
    s_waitcnt lgkmcnt(10)
    v_mfma_f32_32x32x16_bf16 v[48:63], v[136:139], v[72:75], v[48:63]
    ds_read_b64_tr_b16 v[96:97], v14 offset:45056
    ds_read_b64_tr_b16 v[98:99], v14 offset:45312
    s_waitcnt vmcnt(16)
    s_waitcnt lgkmcnt(10)
    v_mfma_f32_32x32x16_bf16 v[16:31], v[140:143], v[76:79], v[16:31]
    ds_read_b64_tr_b16 v[100:101], v14 offset:46080
    ds_read_b64_tr_b16 v[102:103], v14 offset:46336
    s_waitcnt lgkmcnt(10)
    v_mfma_f32_32x32x16_bf16 v[32:47], v[140:143], v[80:83], v[32:47]
    ds_read_b64_tr_b16 v[104:105], v14 offset:47104
    ds_read_b64_tr_b16 v[106:107], v14 offset:47360
    s_waitcnt lgkmcnt(10)
    v_mfma_f32_32x32x16_bf16 v[48:63], v[140:143], v[84:87], v[48:63]
    ds_read_b64_tr_b16 v[108:109], v14 offset:48128
    ds_read_b64_tr_b16 v[110:111], v14 offset:48384
    s_waitcnt lgkmcnt(10)
    v_mfma_f32_32x32x16_bf16 v[16:31], v[168:171], v[88:91], v[16:31]
    s_waitcnt lgkmcnt(8)
    v_mfma_f32_32x32x16_bf16 v[32:47], v[168:171], v[92:95], v[32:47]
    s_waitcnt lgkmcnt(6)
    v_mfma_f32_32x32x16_bf16 v[48:63], v[168:171], v[96:99], v[48:63]
    s_waitcnt lgkmcnt(4)
    v_mfma_f32_32x32x16_bf16 v[16:31], v[172:175], v[100:103], v[16:31]
    s_waitcnt lgkmcnt(2)
    v_mfma_f32_32x32x16_bf16 v[32:47], v[172:175], v[104:107], v[32:47]
    s_waitcnt lgkmcnt(0)
    v_mfma_f32_32x32x16_bf16 v[48:63], v[172:175], v[108:111], v[48:63]
    s_cmp_ge_u32 s6, 86
    s_cbranch_scc1 L_m_drest
    s_mov_b32 s26, 0xbfb8aa3b
    s_mov_b32 s27, 0
    v_add_f32 v166, v166, v167
    s_lshl_b32 s12, s3, 7
    s_add_u32 s12, s12, 131328
    v_mov_b32 v167, v166
    v_and_b32 v8, 31, v1
    v_lshl_add_u32 v8, v8, 2, s12
    v_permlane32_swap_b32 v166, v167
    v_lshl_add_u32 v9, v7, 4, s12
    v_add_f32 v166, v166, v167
    ds_write_b32 v8, v166
    ds_read_b128 v[144:147], v9
    ds_read_b128 v[148:151], v9 offset:32
    ds_read_b128 v[152:155], v9 offset:64
    ds_read_b128 v[156:159], v9 offset:96
    s_waitcnt vmcnt(0)
    s_branch L_m_gc
    L_m_gp:
    s_sleep 4
    buffer_load_dwordx2 v[160:161], v15, s[8:11], s47 offen sc1
    buffer_load_dwordx2 v[162:163], v15, s[8:11], s48 offen sc1
    buffer_load_dwordx2 v[164:165], v15, s[8:11], s49 offen sc1
    s_add_u32 s27, s27, 1
    s_waitcnt vmcnt(0)
    L_m_gc:
    v_and_b32 v8, v161, v163
    v_and_b32 v8, v8, v165
    v_cmp_ne_u32 vcc, 1, v8
    s_cmp_eq_u64 vcc, 0
    s_cbranch_scc1 L_m_gd
    s_cmp_lt_u32 s27, 400000
    s_cbranch_scc1 L_m_gp
    L_m_gd:
    v_and_b32 v116, 0xffff0000, v160
    v_lshlrev_b32 v112, 16, v160
    v_and_b32 v122, 0xffff0000, v162
    v_lshlrev_b32 v118, 16, v162
    v_and_b32 v128, 0xffff0000, v164
    v_lshlrev_b32 v124, 16, v164
    v_rcp_f32 v114, v116
    v_rcp_f32 v120, v122
    v_rcp_f32 v126, v128
    v_sub_f32 v113, 0, v112
    v_sub_f32 v112, 0, v112
    v_mov_b32 v117, v116
    v_mul_f32 v115, s26, v114
    v_mul_f32 v114, s26, v114
    v_sub_f32 v119, 0, v118
    v_sub_f32 v118, 0, v118
    v_mov_b32 v123, v122
    v_mul_f32 v121, s26, v120
    v_mul_f32 v120, s26, v120
    v_sub_f32 v125, 0, v124
    v_sub_f32 v124, 0, v124
    v_mov_b32 v129, v128
    v_mul_f32 v127, s26, v126
    v_mul_f32 v126, s26, v126
    s_mul_i32 s15, s4, 264192
    s_lshl_b32 s12, s6, 10
    s_add_u32 s15, s15, s12
    s_add_u32 s15, s15, s90
    s_waitcnt lgkmcnt(0)
    v_pk_fma_f32 v[16:17], v[144:145], v[112:113], v[16:17]
    v_pk_fma_f32 v[18:19], v[146:147], v[112:113], v[18:19]
    v_pk_fma_f32 v[20:21], v[148:149], v[112:113], v[20:21]
    v_pk_fma_f32 v[22:23], v[150:151], v[112:113], v[22:23]
    v_pk_mul_f32 v[16:17], v[16:17], v[114:115]
    v_pk_mul_f32 v[18:19], v[18:19], v[114:115]
    v_pk_mul_f32 v[20:21], v[20:21], v[114:115]
    v_pk_mul_f32 v[22:23], v[22:23], v[114:115]
    v_exp_f32 v16, v16
    v_exp_f32 v17, v17
    v_exp_f32 v18, v18
    v_exp_f32 v19, v19
    v_exp_f32 v20, v20
    v_exp_f32 v21, v21
    v_exp_f32 v22, v22
    v_exp_f32 v23, v23
    v_pk_fma_f32 v[24:25], v[152:153], v[112:113], v[24:25]
    v_pk_fma_f32 v[26:27], v[154:155], v[112:113], v[26:27]
    v_pk_fma_f32 v[28:29], v[156:157], v[112:113], v[28:29]
    v_pk_fma_f32 v[30:31], v[158:159], v[112:113], v[30:31]
    v_pk_fma_f32 v[16:17], v[16:17], v[116:117], v[116:117]
    v_pk_fma_f32 v[18:19], v[18:19], v[116:117], v[116:117]
    v_pk_fma_f32 v[20:21], v[20:21], v[116:117], v[116:117]
    v_pk_fma_f32 v[22:23], v[22:23], v[116:117], v[116:117]
    v_rcp_f32 v16, v16
    v_rcp_f32 v17, v17
    v_rcp_f32 v18, v18
    v_rcp_f32 v19, v19
    v_rcp_f32 v20, v20
    v_rcp_f32 v21, v21
    v_rcp_f32 v22, v22
    v_rcp_f32 v23, v23
    s_nop 0
    v_pk_mul_f32 v[24:25], v[24:25], v[16:17]
    v_pk_mul_f32 v[26:27], v[26:27], v[18:19]
    v_pk_mul_f32 v[28:29], v[28:29], v[20:21]
    v_pk_mul_f32 v[30:31], v[30:31], v[22:23]
    v_cvt_pk_bf16_f32 v64, v24, v25
    v_cvt_pk_bf16_f32 v65, v26, v27
    v_cvt_pk_bf16_f32 v66, v28, v29
    v_cvt_pk_bf16_f32 v67, v30, v31
    buffer_store_dwordx4 v[64:67], v3, s[8:11], s15 offen sc1
    s_cmp_eq_u32 s4, 21
    s_cbranch_scc1 L_m_pub
    s_add_u32 s15, s15, 88064
    v_pk_fma_f32 v[32:33], v[144:145], v[118:119], v[32:33]
    v_pk_fma_f32 v[34:35], v[146:147], v[118:119], v[34:35]
    v_pk_fma_f32 v[36:37], v[148:149], v[118:119], v[36:37]
    v_pk_fma_f32 v[38:39], v[150:151], v[118:119], v[38:39]
    v_pk_mul_f32 v[32:33], v[32:33], v[120:121]
    v_pk_mul_f32 v[34:35], v[34:35], v[120:121]
    v_pk_mul_f32 v[36:37], v[36:37], v[120:121]
    v_pk_mul_f32 v[38:39], v[38:39], v[120:121]
    v_exp_f32 v32, v32
    v_exp_f32 v33, v33
    v_exp_f32 v34, v34
    v_exp_f32 v35, v35
    v_exp_f32 v36, v36
    v_exp_f32 v37, v37
    v_exp_f32 v38, v38
    v_exp_f32 v39, v39
    v_pk_fma_f32 v[40:41], v[152:153], v[118:119], v[40:41]
    v_pk_fma_f32 v[42:43], v[154:155], v[118:119], v[42:43]
    v_pk_fma_f32 v[44:45], v[156:157], v[118:119], v[44:45]
    v_pk_fma_f32 v[46:47], v[158:159], v[118:119], v[46:47]
    v_pk_fma_f32 v[32:33], v[32:33], v[122:123], v[122:123]
    v_pk_fma_f32 v[34:35], v[34:35], v[122:123], v[122:123]
    v_pk_fma_f32 v[36:37], v[36:37], v[122:123], v[122:123]
    v_pk_fma_f32 v[38:39], v[38:39], v[122:123], v[122:123]
    v_rcp_f32 v32, v32
    v_rcp_f32 v33, v33
    v_rcp_f32 v34, v34
    v_rcp_f32 v35, v35
    v_rcp_f32 v36, v36
    v_rcp_f32 v37, v37
    v_rcp_f32 v38, v38
    v_rcp_f32 v39, v39
    s_nop 0
    v_pk_mul_f32 v[40:41], v[40:41], v[32:33]
    v_pk_mul_f32 v[42:43], v[42:43], v[34:35]
    v_pk_mul_f32 v[44:45], v[44:45], v[36:37]
    v_pk_mul_f32 v[46:47], v[46:47], v[38:39]
    v_cvt_pk_bf16_f32 v68, v40, v41
    v_cvt_pk_bf16_f32 v69, v42, v43
    v_cvt_pk_bf16_f32 v70, v44, v45
    v_cvt_pk_bf16_f32 v71, v46, v47
    buffer_store_dwordx4 v[68:71], v3, s[8:11], s15 offen sc1
    s_add_u32 s15, s15, 88064
    v_pk_fma_f32 v[48:49], v[144:145], v[124:125], v[48:49]
    v_pk_fma_f32 v[50:51], v[146:147], v[124:125], v[50:51]
    v_pk_fma_f32 v[52:53], v[148:149], v[124:125], v[52:53]
    v_pk_fma_f32 v[54:55], v[150:151], v[124:125], v[54:55]
    v_pk_mul_f32 v[48:49], v[48:49], v[126:127]
    v_pk_mul_f32 v[50:51], v[50:51], v[126:127]
    v_pk_mul_f32 v[52:53], v[52:53], v[126:127]
    v_pk_mul_f32 v[54:55], v[54:55], v[126:127]
    v_exp_f32 v48, v48
    v_exp_f32 v49, v49
    v_exp_f32 v50, v50
    v_exp_f32 v51, v51
    v_exp_f32 v52, v52
    v_exp_f32 v53, v53
    v_exp_f32 v54, v54
    v_exp_f32 v55, v55
    v_pk_fma_f32 v[56:57], v[152:153], v[124:125], v[56:57]
    v_pk_fma_f32 v[58:59], v[154:155], v[124:125], v[58:59]
    v_pk_fma_f32 v[60:61], v[156:157], v[124:125], v[60:61]
    v_pk_fma_f32 v[62:63], v[158:159], v[124:125], v[62:63]
    v_pk_fma_f32 v[48:49], v[48:49], v[128:129], v[128:129]
    v_pk_fma_f32 v[50:51], v[50:51], v[128:129], v[128:129]
    v_pk_fma_f32 v[52:53], v[52:53], v[128:129], v[128:129]
    v_pk_fma_f32 v[54:55], v[54:55], v[128:129], v[128:129]
    v_rcp_f32 v48, v48
    v_rcp_f32 v49, v49
    v_rcp_f32 v50, v50
    v_rcp_f32 v51, v51
    v_rcp_f32 v52, v52
    v_rcp_f32 v53, v53
    v_rcp_f32 v54, v54
    v_rcp_f32 v55, v55
    s_nop 0
    v_pk_mul_f32 v[56:57], v[56:57], v[48:49]
    v_pk_mul_f32 v[58:59], v[58:59], v[50:51]
    v_pk_mul_f32 v[60:61], v[60:61], v[52:53]
    v_pk_mul_f32 v[62:63], v[62:63], v[54:55]
    v_cvt_pk_bf16_f32 v72, v56, v57
    v_cvt_pk_bf16_f32 v73, v58, v59
    v_cvt_pk_bf16_f32 v74, v60, v61
    v_cvt_pk_bf16_f32 v75, v62, v63
    buffer_store_dwordx4 v[72:75], v3, s[8:11], s15 offen sc1
    s_add_u32 s15, s15, 88064
    L_m_pub:
    s_waitcnt vmcnt(0)
    s_branch L_m_drest
L_m_dall:
    s_and_b32 s30, s2, 7
    s_lshr_b32 s31, s2, 3
    s_lshl_b32 s30, s30, 2
    s_lshr_b32 s12, s31, 3
    s_add_u32 s30, s30, s12
    s_and_b32 s31, s31, 7
    s_bfe_u32 s12, s3, 0x10001
    s_lshl_b32 s32, s31, 1
    s_add_u32 s32, s32, s12
    s_and_b32 s12, s3, 1
    s_lshl_b32 s33, s30, 1
    s_add_u32 s33, s33, s12
    s_xor_b32 s12, s32, 1
    s_mul_i32 s34, s32, 88064
    s_mul_i32 s35, s12, 88064
    s_xor_b32 s12, s33, 1
    s_mul_i32 s36, s33, 88064
    s_mul_i32 s37, s12, 88064
    s_lshl_b32 s12, s3, 10
    s_add_u32 s13, s12, 11534336
    s_add_u32 s34, s34, s13
    s_add_u32 s35, s35, s13
    s_add_u32 s13, s12, s90
    s_add_u32 s36, s36, s13
    s_add_u32 s37, s37, s13
    s_cmp_ge_u32 s3, 6
    s_cselect_b32 s22, 0, s10
    s_add_u32 s14, s34, 8192
    buffer_load_dwordx4 v[176:179], v3, s[8:11], s14 offen sc1
    s_add_u32 s14, s35, 8192
    buffer_load_dwordx4 v[180:183], v3, s[8:11], s14 offen sc1
    s_add_u32 s14, s34, 16384
    buffer_load_dwordx4 v[184:187], v3, s[8:11], s14 offen sc1
    s_add_u32 s14, s35, 16384
    buffer_load_dwordx4 v[188:191], v3, s[8:11], s14 offen sc1
    s_add_u32 s14, s34, 24576
    buffer_load_dwordx4 v[192:195], v3, s[8:11], s14 offen sc1
    s_add_u32 s14, s35, 24576
    buffer_load_dwordx4 v[196:199], v3, s[8:11], s14 offen sc1
    s_add_u32 s14, s34, 32768
    buffer_load_dwordx4 v[200:203], v3, s[8:11], s14 offen sc1
    s_add_u32 s14, s35, 32768
    buffer_load_dwordx4 v[204:207], v3, s[8:11], s14 offen sc1
    s_add_u32 s14, s34, 40960
    buffer_load_dwordx4 v[208:211], v3, s[8:11], s14 offen sc1
    s_add_u32 s14, s35, 40960
    buffer_load_dwordx4 v[212:215], v3, s[8:11], s14 offen sc1
    s_add_u32 s14, s34, 49152
    buffer_load_dwordx4 v[216:219], v3, s[8:11], s14 offen sc1
    s_add_u32 s14, s35, 49152
    buffer_load_dwordx4 v[220:223], v3, s[8:11], s14 offen sc1
    s_add_u32 s14, s34, 57344
    buffer_load_dwordx4 v[224:227], v3, s[8:11], s14 offen sc1
    s_add_u32 s14, s35, 57344
    buffer_load_dwordx4 v[228:231], v3, s[8:11], s14 offen sc1
    s_add_u32 s14, s34, 65536
    buffer_load_dwordx4 v[232:235], v3, s[8:11], s14 offen sc1
    s_add_u32 s14, s35, 65536
    buffer_load_dwordx4 v[236:239], v3, s[8:11], s14 offen sc1
    s_add_u32 s14, s34, 73728
    buffer_load_dwordx4 v[240:243], v3, s[8:11], s14 offen sc1
    s_add_u32 s14, s35, 73728
    buffer_load_dwordx4 v[244:247], v3, s[8:11], s14 offen sc1
    s_add_u32 s14, s34, 81920
    buffer_load_dwordx4 v[248:251], v3, s[20:23], s14 offen sc1
    s_add_u32 s14, s35, 81920
    buffer_load_dwordx4 v[252:255], v3, s[20:23], s14 offen sc1
L_m_drest:
    s_waitcnt lgkmcnt(0)
    s_barrier
    s_cmp_lg_u32 s3, 0
    s_cbranch_scc1 L_hf_np
    s_cmp_lt_u32 s2, 14
    s_cbranch_scc1 L_hf_np
    s_lshl_b32 s15, s4, 9
    s_lshl_b32 s12, s5, 2
    s_add_u32 s15, s15, s12
    s_add_u32 s15, s15, s91
    v_lshlrev_b32 v8, 7, v1
    v_mov_b32 v9, 1
    s_mov_b64 exec, 15
    buffer_store_dword v9, v8, s[8:11], s15 offen sc1
    s_mov_b64 exec, -1
    L_hf_np:
    s_add_u32 s14, s34, 0
    buffer_load_dwordx4 v[168:171], v3, s[8:11], s14 offen sc1
    s_add_u32 s14, s35, 0
    buffer_load_dwordx4 v[172:175], v3, s[8:11], s14 offen sc1
    v_mov_b32 v16, 0
    v_mov_b32 v17, 0
    v_mov_b32 v18, 0
    v_mov_b32 v19, 0
    v_mov_b32 v20, 0
    v_mov_b32 v21, 0
    v_mov_b32 v22, 0
    v_mov_b32 v23, 0
    v_mov_b32 v24, 0
    v_mov_b32 v25, 0
    v_mov_b32 v26, 0
    v_mov_b32 v27, 0
    v_mov_b32 v28, 0
    v_mov_b32 v29, 0
    v_mov_b32 v30, 0
    v_mov_b32 v31, 0
    v_mov_b32 v32, 0
    v_mov_b32 v33, 0
    v_mov_b32 v34, 0
    v_mov_b32 v35, 0
    v_mov_b32 v36, 0
    v_mov_b32 v37, 0
    v_mov_b32 v38, 0
    v_mov_b32 v39, 0
    v_mov_b32 v40, 0
    v_mov_b32 v41, 0
    v_mov_b32 v42, 0
    v_mov_b32 v43, 0
    v_mov_b32 v44, 0
    v_mov_b32 v45, 0
    v_mov_b32 v46, 0
    v_mov_b32 v47, 0
    v_mov_b32 v48, 0
    v_mov_b32 v49, 0
    v_mov_b32 v50, 0
    v_mov_b32 v51, 0
    v_mov_b32 v52, 0
    v_mov_b32 v53, 0
    v_mov_b32 v54, 0
    v_mov_b32 v55, 0
    v_mov_b32 v56, 0
    v_mov_b32 v57, 0
    v_mov_b32 v58, 0
    v_mov_b32 v59, 0
    v_mov_b32 v60, 0
    v_mov_b32 v61, 0
    v_mov_b32 v62, 0
    v_mov_b32 v63, 0
    v_mov_b32 v64, 0
    v_mov_b32 v65, 0
    v_mov_b32 v66, 0
    v_mov_b32 v67, 0
    v_mov_b32 v68, 0
    v_mov_b32 v69, 0
    v_mov_b32 v70, 0
    v_mov_b32 v71, 0
    v_mov_b32 v72, 0
    v_mov_b32 v73, 0
    v_mov_b32 v74, 0
    v_mov_b32 v75, 0
    v_mov_b32 v76, 0
    v_mov_b32 v77, 0
    v_mov_b32 v78, 0
    v_mov_b32 v79, 0
    s_lshl_b32 s12, s30, 1
    s_mul_i32 s13, s12, 171
    s_lshr_b32 s13, s13, 9
    s_add_u32 s12, s12, 1
    s_mul_i32 s12, s12, 171
    s_lshr_b32 s12, s12, 9
    s_lshl_b32 s13, s13, 9
    s_lshl_b32 s12, s12, 9
    s_and_b32 s38, s31, 3
    s_lshl_b32 s38, s38, 7
    s_add_u32 s38, s38, s91
    v_and_b32 v8, 15, v1
    v_and_b32 v9, 16, v1
    v_mov_b32 v10, s13
    v_mov_b32 v11, s12
    v_cmp_eq_u32 vcc, 0, v9
    v_cmp_gt_u32 s[26:27], 11, v8
    s_nop 0
    v_cndmask_b32 v10, v11, v10, vcc
    v_lshl_add_u32 v10, v8, 2, v10
    v_and_b32 v6, 31, v1
    v_lshlrev_b32 v5, 8, v7
    v_lshl_add_u32 v5, v6, 1, v5
    s_lshl_b32 s24, s32, 11
    s_lshl_b32 s25, s33, 15
    s_add_u32 s24, s24, s25
    s_lshr_b32 s12, s3, 2
    s_lshl_b32 s12, s12, 10
    s_add_u32 s24, s24, s12
    s_add_u32 s25, s24, s92
    s_add_u32 s24, s24, s87
    s_mov_b32 s13, 0
    s_cmp_eq_u32 s3, 0
    s_cbranch_scc0 L_m_hr
    L_m_hq:
    buffer_load_dword v12, v10, s[8:11], s38 offen sc1
    s_add_u32 s13, s13, 1
    s_waitcnt vmcnt(0)
    v_cmp_ne_u32 vcc, 1, v12
    s_and_b64 vcc, vcc, s[26:27]
    s_cbranch_scc0 L_m_hr
    s_cmp_ge_u32 s13, 400000
    s_cbranch_scc1 L_m_hr
    s_sleep 1
    s_branch L_m_hq
    L_m_hr:
    s_barrier
    L_m_hd:
    s_mov_b32 s22, 31457280
    v_mov_b32 v12, v3
    buffer_load_dwordx4 v[80:83], v12, s[20:23], s36 offen sc1
    buffer_load_dwordx4 v[84:87], v12, s[20:23], s37 offen sc1
    v_add_u32 v12, 8192, v12
    buffer_load_dwordx4 v[88:91], v12, s[20:23], s36 offen sc1
    buffer_load_dwordx4 v[92:95], v12, s[20:23], s37 offen sc1
    v_add_u32 v12, 8192, v12
    buffer_load_dwordx4 v[96:99], v12, s[20:23], s36 offen sc1
    buffer_load_dwordx4 v[100:103], v12, s[20:23], s37 offen sc1
    v_add_u32 v12, 8192, v12
    buffer_load_dwordx4 v[104:107], v12, s[20:23], s36 offen sc1
    buffer_load_dwordx4 v[108:111], v12, s[20:23], s37 offen sc1
    v_add_u32 v12, 8192, v12
    buffer_load_dwordx4 v[112:115], v12, s[20:23], s36 offen sc1
    buffer_load_dwordx4 v[116:119], v12, s[20:23], s37 offen sc1
    v_add_u32 v12, 8192, v12
    buffer_load_dwordx4 v[120:123], v12, s[20:23], s36 offen sc1
    buffer_load_dwordx4 v[124:127], v12, s[20:23], s37 offen sc1
    v_add_u32 v12, 8192, v12
    buffer_load_ushort v128, v5, s[8:11], s24 offen offset:0 sc1
    buffer_load_ushort v129, v5, s[8:11], s24 offen offset:64 sc1
    buffer_load_ushort v130, v5, s[8:11], s24 offen offset:128 sc1
    buffer_load_ushort v131, v5, s[8:11], s24 offen offset:192 sc1
    buffer_load_ushort v132, v5, s[8:11], s24 offen offset:512 sc1
    buffer_load_ushort v133, v5, s[8:11], s24 offen offset:576 sc1
    buffer_load_ushort v134, v5, s[8:11], s24 offen offset:640 sc1
    buffer_load_ushort v135, v5, s[8:11], s24 offen offset:704 sc1
    s_and_b32 s13, s3, 3
    s_xor_b32 s12, s13, 0
    s_lshl_b32 s12, s12, 14
    s_lshl_b32 s15, s3, 11
    s_add_u32 s12, s12, s15
    v_add_u32 v8, s12, v3
    s_xor_b32 s12, s13, 1
    s_lshl_b32 s12, s12, 14
    s_lshl_b32 s15, s3, 11
    s_add_u32 s12, s12, s15
    v_add_u32 v9, s12, v3
    s_xor_b32 s12, s13, 2
    s_lshl_b32 s12, s12, 14
    s_lshl_b32 s15, s3, 11
    s_add_u32 s12, s12, s15
    v_add_u32 v10, s12, v3
    s_xor_b32 s12, s13, 3
    s_lshl_b32 s12, s12, 14
    s_lshl_b32 s15, s3, 11
    s_add_u32 s12, s12, s15
    v_add_u32 v11, s12, v3
    s_lshl_b32 s12, s3, 14
    v_add_u32 v13, s12, v3
    v_add_u32 v14, 0x10000, v8
    v_add_u32 v15, 0x10000, v9
    v_add_u32 v0, 0x10000, v10
    v_add_u32 v2, 0x10000, v11
    s_waitcnt vmcnt(18)
    v_mfma_f32_32x32x16_bf16 v[16:31], v[168:171], v[80:83], v[16:31]
    v_mfma_f32_32x32x16_bf16 v[32:47], v[168:171], v[84:87], v[32:47]
    v_mfma_f32_32x32x16_bf16 v[48:63], v[172:175], v[80:83], v[48:63]
    v_mfma_f32_32x32x16_bf16 v[64:79], v[172:175], v[84:87], v[64:79]
    s_waitcnt vmcnt(16)
    v_mfma_f32_32x32x16_bf16 v[16:31], v[176:179], v[88:91], v[16:31]
    v_mfma_f32_32x32x16_bf16 v[32:47], v[176:179], v[92:95], v[32:47]
    v_mfma_f32_32x32x16_bf16 v[48:63], v[180:183], v[88:91], v[48:63]
    v_mfma_f32_32x32x16_bf16 v[64:79], v[180:183], v[92:95], v[64:79]
    buffer_load_dwordx4 v[80:83], v12, s[20:23], s36 offen sc1
    buffer_load_dwordx4 v[84:87], v12, s[20:23], s37 offen sc1
    v_add_u32 v12, 8192, v12
    s_waitcnt vmcnt(16)
    v_mfma_f32_32x32x16_bf16 v[16:31], v[184:187], v[96:99], v[16:31]
    v_mfma_f32_32x32x16_bf16 v[32:47], v[184:187], v[100:103], v[32:47]
    v_mfma_f32_32x32x16_bf16 v[48:63], v[188:191], v[96:99], v[48:63]
    v_mfma_f32_32x32x16_bf16 v[64:79], v[188:191], v[100:103], v[64:79]
    buffer_load_dwordx4 v[88:91], v12, s[20:23], s36 offen sc1
    buffer_load_dwordx4 v[92:95], v12, s[20:23], s37 offen sc1
    v_add_u32 v12, 8192, v12
    s_waitcnt vmcnt(16)
    v_mfma_f32_32x32x16_bf16 v[16:31], v[192:195], v[104:107], v[16:31]
    v_mfma_f32_32x32x16_bf16 v[32:47], v[192:195], v[108:111], v[32:47]
    v_mfma_f32_32x32x16_bf16 v[48:63], v[196:199], v[104:107], v[48:63]
    v_mfma_f32_32x32x16_bf16 v[64:79], v[196:199], v[108:111], v[64:79]
    buffer_load_dwordx4 v[96:99], v12, s[20:23], s36 offen sc1
    buffer_load_dwordx4 v[100:103], v12, s[20:23], s37 offen sc1
    v_add_u32 v12, 8192, v12
    s_waitcnt vmcnt(16)
    v_mfma_f32_32x32x16_bf16 v[16:31], v[200:203], v[112:115], v[16:31]
    v_mfma_f32_32x32x16_bf16 v[32:47], v[200:203], v[116:119], v[32:47]
    v_mfma_f32_32x32x16_bf16 v[48:63], v[204:207], v[112:115], v[48:63]
    v_mfma_f32_32x32x16_bf16 v[64:79], v[204:207], v[116:119], v[64:79]
    buffer_load_dwordx4 v[104:107], v12, s[20:23], s36 offen sc1
    buffer_load_dwordx4 v[108:111], v12, s[20:23], s37 offen sc1
    v_add_u32 v12, 8192, v12
    s_waitcnt vmcnt(16)
    v_mfma_f32_32x32x16_bf16 v[16:31], v[208:211], v[120:123], v[16:31]
    v_mfma_f32_32x32x16_bf16 v[32:47], v[208:211], v[124:127], v[32:47]
    v_mfma_f32_32x32x16_bf16 v[48:63], v[212:215], v[120:123], v[48:63]
    v_mfma_f32_32x32x16_bf16 v[64:79], v[212:215], v[124:127], v[64:79]
    s_cmp_ge_u32 s3, 6
    s_cselect_b32 s22, 0, s22
    buffer_load_dwordx4 v[112:115], v12, s[20:23], s36 offen sc1
    buffer_load_dwordx4 v[116:119], v12, s[20:23], s37 offen sc1
    v_add_u32 v12, 8192, v12
    s_waitcnt vmcnt(8)
    v_mfma_f32_32x32x16_bf16 v[16:31], v[216:219], v[80:83], v[16:31]
    v_mfma_f32_32x32x16_bf16 v[32:47], v[216:219], v[84:87], v[32:47]
    v_mfma_f32_32x32x16_bf16 v[48:63], v[220:223], v[80:83], v[48:63]
    v_mfma_f32_32x32x16_bf16 v[64:79], v[220:223], v[84:87], v[64:79]
    s_waitcnt vmcnt(6)
    v_mfma_f32_32x32x16_bf16 v[16:31], v[224:227], v[88:91], v[16:31]
    v_mfma_f32_32x32x16_bf16 v[32:47], v[224:227], v[92:95], v[32:47]
    v_mfma_f32_32x32x16_bf16 v[48:63], v[228:231], v[88:91], v[48:63]
    v_mfma_f32_32x32x16_bf16 v[64:79], v[228:231], v[92:95], v[64:79]
    s_waitcnt vmcnt(4)
    v_mfma_f32_32x32x16_bf16 v[16:31], v[232:235], v[96:99], v[16:31]
    v_mfma_f32_32x32x16_bf16 v[32:47], v[232:235], v[100:103], v[32:47]
    v_mfma_f32_32x32x16_bf16 v[48:63], v[236:239], v[96:99], v[48:63]
    v_mfma_f32_32x32x16_bf16 v[64:79], v[236:239], v[100:103], v[64:79]
    s_waitcnt vmcnt(2)
    v_mfma_f32_32x32x16_bf16 v[16:31], v[240:243], v[104:107], v[16:31]
    v_mfma_f32_32x32x16_bf16 v[32:47], v[240:243], v[108:111], v[32:47]
    v_mfma_f32_32x32x16_bf16 v[48:63], v[244:247], v[104:107], v[48:63]
    v_mfma_f32_32x32x16_bf16 v[64:79], v[244:247], v[108:111], v[64:79]
    s_waitcnt vmcnt(0)
    v_mfma_f32_32x32x16_bf16 v[16:31], v[248:251], v[112:115], v[16:31]
    v_mfma_f32_32x32x16_bf16 v[32:47], v[248:251], v[116:119], v[32:47]
    v_mfma_f32_32x32x16_bf16 v[48:63], v[252:255], v[112:115], v[48:63]
    v_mfma_f32_32x32x16_bf16 v[64:79], v[252:255], v[116:119], v[64:79]
    s_nop 3
    v_lshlrev_b32 v128, 16, v128
    v_lshlrev_b32 v129, 16, v129
    v_lshlrev_b32 v130, 16, v130
    v_lshlrev_b32 v131, 16, v131
    v_lshlrev_b32 v132, 16, v132
    v_lshlrev_b32 v133, 16, v133
    v_lshlrev_b32 v134, 16, v134
    v_lshlrev_b32 v135, 16, v135
    ds_write_b128 v8, v[16:19] offset:0
    ds_write_b128 v8, v[20:23] offset:1024
    ds_write_b128 v14, v[24:27] offset:0
    ds_write_b128 v14, v[28:31] offset:1024
    ds_write_b128 v9, v[32:35] offset:0
    ds_write_b128 v9, v[36:39] offset:1024
    ds_write_b128 v15, v[40:43] offset:0
    ds_write_b128 v15, v[44:47] offset:1024
    ds_write_b128 v10, v[48:51] offset:0
    ds_write_b128 v10, v[52:55] offset:1024
    ds_write_b128 v0, v[56:59] offset:0
    ds_write_b128 v0, v[60:63] offset:1024
    ds_write_b128 v11, v[64:67] offset:0
    ds_write_b128 v11, v[68:71] offset:1024
    ds_write_b128 v2, v[72:75] offset:0
    s_waitcnt lgkmcnt(14)
    ds_write_b128 v2, v[76:79] offset:1024
    s_waitcnt lgkmcnt(0)
    s_barrier
    ds_read_b128 v[16:19], v13 offset:0
    ds_read_b128 v[20:23], v13 offset:2048
    ds_read_b128 v[24:27], v13 offset:4096
    ds_read_b128 v[28:31], v13 offset:6144
    ds_read_b128 v[32:35], v13 offset:8192
    ds_read_b128 v[36:39], v13 offset:10240
    ds_read_b128 v[40:43], v13 offset:12288
    ds_read_b128 v[44:47], v13 offset:14336
    ds_read_b128 v[48:51], v13 offset:1024
    ds_read_b128 v[52:55], v13 offset:3072
    ds_read_b128 v[56:59], v13 offset:5120
    ds_read_b128 v[60:63], v13 offset:7168
    ds_read_b128 v[64:67], v13 offset:9216
    ds_read_b128 v[68:71], v13 offset:11264
    ds_read_b128 v[72:75], v13 offset:13312
    s_waitcnt lgkmcnt(14)
    ds_read_b128 v[76:79], v13 offset:15360
    s_waitcnt lgkmcnt(14)
    v_pk_add_f32 v[16:17], v[16:17], v[20:21]
    v_pk_add_f32 v[18:19], v[18:19], v[22:23]
    s_waitcnt lgkmcnt(12)
    v_pk_add_f32 v[24:25], v[24:25], v[28:29]
    v_pk_add_f32 v[26:27], v[26:27], v[30:31]
    s_waitcnt lgkmcnt(10)
    v_pk_add_f32 v[32:33], v[32:33], v[36:37]
    v_pk_add_f32 v[34:35], v[34:35], v[38:39]
    s_waitcnt lgkmcnt(8)
    v_pk_add_f32 v[40:41], v[40:41], v[44:45]
    v_pk_add_f32 v[42:43], v[42:43], v[46:47]
    v_pk_add_f32 v[16:17], v[16:17], v[24:25]
    v_pk_add_f32 v[18:19], v[18:19], v[26:27]
    v_pk_add_f32 v[32:33], v[32:33], v[40:41]
    v_pk_add_f32 v[34:35], v[34:35], v[42:43]
    v_pk_add_f32 v[16:17], v[16:17], v[32:33]
    v_pk_add_f32 v[18:19], v[18:19], v[34:35]
    v_cvt_pk_bf16_f32 v144, v16, v17
    v_cvt_pk_bf16_f32 v145, v18, v19
    v_lshlrev_b32 v16, 16, v144
    v_and_b32 v17, 0xffff0000, v144
    v_lshlrev_b32 v18, 16, v145
    v_and_b32 v19, 0xffff0000, v145
    v_pk_add_f32 v[16:17], v[16:17], v[128:129]
    v_pk_add_f32 v[18:19], v[18:19], v[130:131]
    v_cvt_pk_bf16_f32 v144, v16, v17
    v_cvt_pk_bf16_f32 v145, v18, v19
    s_waitcnt lgkmcnt(6)
    v_pk_add_f32 v[48:49], v[48:49], v[52:53]
    v_pk_add_f32 v[50:51], v[50:51], v[54:55]
    s_waitcnt lgkmcnt(4)
    v_pk_add_f32 v[56:57], v[56:57], v[60:61]
    v_pk_add_f32 v[58:59], v[58:59], v[62:63]
    s_waitcnt lgkmcnt(2)
    v_pk_add_f32 v[64:65], v[64:65], v[68:69]
    v_pk_add_f32 v[66:67], v[66:67], v[70:71]
    s_waitcnt lgkmcnt(0)
    v_pk_add_f32 v[72:73], v[72:73], v[76:77]
    v_pk_add_f32 v[74:75], v[74:75], v[78:79]
    v_pk_add_f32 v[48:49], v[48:49], v[56:57]
    v_pk_add_f32 v[50:51], v[50:51], v[58:59]
    v_pk_add_f32 v[64:65], v[64:65], v[72:73]
    v_pk_add_f32 v[66:67], v[66:67], v[74:75]
    v_pk_add_f32 v[48:49], v[48:49], v[64:65]
    v_pk_add_f32 v[50:51], v[50:51], v[66:67]
    v_cvt_pk_bf16_f32 v146, v48, v49
    v_cvt_pk_bf16_f32 v147, v50, v51
    v_lshlrev_b32 v48, 16, v146
    v_and_b32 v49, 0xffff0000, v146
    v_lshlrev_b32 v50, 16, v147
    v_and_b32 v51, 0xffff0000, v147
    v_pk_add_f32 v[48:49], v[48:49], v[132:133]
    v_pk_add_f32 v[50:51], v[50:51], v[134:135]
    v_cvt_pk_bf16_f32 v146, v48, v49
    v_cvt_pk_bf16_f32 v147, v50, v51
    s_cmp_eq_u32 s93, 1
    s_cbranch_scc1 L_m_out
    v_mov_b32 v14, 0x3f803f80
    s_lshl_b32 s12, s3, 14
    v_add_u32 v8, s12, v5
    v_mov_b32 v12, 0
    v_mov_b32 v9, 0
    ds_write_b16 v8, v144 offset:0
    ds_write_b16_d16_hi v8, v144 offset:64
    ds_write_b16 v8, v145 offset:128
    ds_write_b16_d16_hi v8, v145 offset:192
    ds_write_b16 v8, v146 offset:512
    ds_write_b16_d16_hi v8, v146 offset:576
    ds_write_b16 v8, v147 offset:640
    ds_write_b16_d16_hi v8, v147 offset:704
    ds_read_b128 v[16:19], v13
    v_dot2_f32_bf16 v12, v144, v14, v12
    v_dot2_f32_bf16 v9, v144, v144, v9
    v_dot2_f32_bf16 v12, v145, v14, v12
    v_dot2_f32_bf16 v9, v145, v145, v9
    v_dot2_f32_bf16 v12, v146, v14, v12
    v_dot2_f32_bf16 v9, v146, v146, v9
    v_dot2_f32_bf16 v12, v147, v14, v12
    v_dot2_f32_bf16 v9, v147, v147, v9
    v_lshlrev_b32 v5, 3, v6
    v_lshl_add_u32 v5, v7, 2, v5
    s_lshl_b32 s12, s33, 8
    v_permlane32_swap_b32 v12, v9
    s_add_u32 s12, s12, 8404992
    s_waitcnt lgkmcnt(0)
    buffer_store_dwordx4 v[16:19], v3, s[8:11], s25 offen sc1
    v_add_f32 v12, v12, v9
    buffer_atomic_add_f32 v12, v5, s[8:11], s12 offen
    s_lshl_b32 s12, s2, 2
    s_add_u32 s12, s12, 8503296
    v_lshlrev_b32 v8, 10, v1
    ds_read_b32 v9, v4 offset:64
    s_waitcnt vmcnt(0) lgkmcnt(0)
    s_barrier
    s_cmp_lg_u32 s3, 0
    s_cbranch_scc1 L_lf_np
    s_mov_b64 exec, 0xff
    buffer_store_dword v9, v8, s[8:11], s12 offen sc1
    s_mov_b64 exec, -1
    L_lf_np:
    s_mov_b64 exec, -1
    s_mov_b32 s86, 4194304
    s_mov_b32 s87, 6291456
    s_mov_b32 s88, 8404992
    s_mov_b32 s89, 8441856
    s_mov_b32 s90, 24117248
    s_mov_b32 s91, 8474624
    s_mov_b32 s92, 0
    s_mov_b32 s93, 1
    s_mov_b32 s94, 8495104
    s_mov_b32 s95, 6
    s_branch L_layer
    L_m_out:
    s_mov_b32 s28, s96
    s_mov_b32 s29, s97
    s_mov_b32 s30, 2097152
    s_mov_b32 s31, 0x00020000
    v_lshlrev_b32 v5, 10, v6
    v_lshl_add_u32 v5, v7, 4, v5
    s_lshl_b32 s25, s33, 15
    s_lshl_b32 s12, s32, 6
    s_add_u32 s25, s25, s12
    s_lshr_b32 s12, s3, 2
    s_lshl_b32 s12, s12, 5
    s_add_u32 s25, s25, s12
    v_permlane32_swap_b32 v144, v146
    v_permlane32_swap_b32 v145, v147
    buffer_store_dwordx4 v[144:147], v5, s[28:31], s25 offen
    s_branch L_mega_end
L_m_prod:
    s_mul_i32 s4, s2, 5
    s_min_u32 s4, s4, 60
    s_lshl_b32 s12, s4, 15
    s_lshl_b32 s13, s3, 10
    s_add_u32 s12, s12, s13
    s_mov_b32 s26, 2097152
    s_mov_b32 s27, 0x00020000
    s_add_u32 s24, s18, s87
    s_addc_u32 s25, s19, 0
    s_lshl_b32 s5, s3, 14
    v_and_b32 v6, 15, v1
    v_lshrrev_b32 v12, 2, v6
    v_lshl_add_u32 v12, v7, 3, v12
    v_lshlrev_b32 v12, 6, v12
    v_and_b32 v8, 3, v6
    v_lshl_add_u32 v12, v8, 3, v12
    v_and_b32 v8, 16, v1
    v_lshl_add_u32 v12, v8, 1, v12
    v_add_u32 v12, s5, v12
    v_mov_b32 v13, 0x3f803f80
    v_mov_b32 v16, 0
    v_mov_b32 v17, 0
    v_mov_b32 v18, 0
    v_mov_b32 v19, 0
    v_mov_b32 v20, 0
    v_mov_b32 v21, 0
    v_mov_b32 v22, 0
    v_mov_b32 v23, 0
    v_mov_b32 v24, 0
    v_mov_b32 v25, 0
    s_mov_b32 s13, 0
    s_add_u32 m0, s5, 0
    s_add_u32 s14, s12, 0
    buffer_load_dwordx4 v3, s[24:27], s14 offen sc1 lds
    s_add_u32 m0, s5, 1024
    s_add_u32 s14, s12, 8192
    buffer_load_dwordx4 v3, s[24:27], s14 offen sc1 lds
    s_add_u32 m0, s5, 2048
    s_add_u32 s14, s12, 16384
    buffer_load_dwordx4 v3, s[24:27], s14 offen sc1 lds
    s_add_u32 m0, s5, 3072
    s_add_u32 s14, s12, 24576
    buffer_load_dwordx4 v3, s[24:27], s14 offen sc1 lds
    s_waitcnt vmcnt(3)
    ds_read_b64_tr_b16 v[32:33], v12 offset:0
    ds_read_b64_tr_b16 v[34:35], v12 offset:256
    s_waitcnt vmcnt(2)
    ds_read_b64_tr_b16 v[36:37], v12 offset:1024
    ds_read_b64_tr_b16 v[38:39], v12 offset:1280
    s_waitcnt vmcnt(1)
    ds_read_b64_tr_b16 v[40:41], v12 offset:2048
    ds_read_b64_tr_b16 v[42:43], v12 offset:2304
    s_waitcnt vmcnt(0)
    ds_read_b64_tr_b16 v[44:45], v12 offset:3072
    ds_read_b64_tr_b16 v[46:47], v12 offset:3328
    s_waitcnt lgkmcnt(6)
    v_dot2_f32_bf16 v16, v32, v13, v16
    v_dot2_f32_bf16 v17, v32, v32, v17
    v_dot2_f32_bf16 v16, v33, v13, v16
    v_dot2_f32_bf16 v17, v33, v33, v17
    v_dot2_f32_bf16 v16, v34, v13, v16
    v_dot2_f32_bf16 v17, v34, v34, v17
    v_dot2_f32_bf16 v16, v35, v13, v16
    v_dot2_f32_bf16 v17, v35, v35, v17
    s_waitcnt lgkmcnt(4)
    v_dot2_f32_bf16 v16, v36, v13, v16
    v_dot2_f32_bf16 v17, v36, v36, v17
    v_dot2_f32_bf16 v16, v37, v13, v16
    v_dot2_f32_bf16 v17, v37, v37, v17
    v_dot2_f32_bf16 v16, v38, v13, v16
    v_dot2_f32_bf16 v17, v38, v38, v17
    v_dot2_f32_bf16 v16, v39, v13, v16
    v_dot2_f32_bf16 v17, v39, v39, v17
    s_waitcnt lgkmcnt(2)
    v_dot2_f32_bf16 v16, v40, v13, v16
    v_dot2_f32_bf16 v17, v40, v40, v17
    v_dot2_f32_bf16 v16, v41, v13, v16
    v_dot2_f32_bf16 v17, v41, v41, v17
    v_dot2_f32_bf16 v16, v42, v13, v16
    v_dot2_f32_bf16 v17, v42, v42, v17
    v_dot2_f32_bf16 v16, v43, v13, v16
    v_dot2_f32_bf16 v17, v43, v43, v17
    s_waitcnt lgkmcnt(0)
    v_dot2_f32_bf16 v16, v44, v13, v16
    v_dot2_f32_bf16 v17, v44, v44, v17
    v_dot2_f32_bf16 v16, v45, v13, v16
    v_dot2_f32_bf16 v17, v45, v45, v17
    v_dot2_f32_bf16 v16, v46, v13, v16
    v_dot2_f32_bf16 v17, v46, v46, v17
    v_dot2_f32_bf16 v16, v47, v13, v16
    v_dot2_f32_bf16 v17, v47, v47, v17
    s_nop 2
L_pv0:
    v_cmp_u_f32 vcc, v17, v17
    s_cmp_eq_u64 vcc, 0
    s_cbranch_scc1 L_po0
    s_add_u32 s13, s13, 1
    s_cmp_ge_u32 s13, 200000
    s_cbranch_scc1 L_po0
    s_sleep 3
    s_add_u32 m0, s5, 0
    s_add_u32 s14, s12, 0
    buffer_load_dwordx4 v3, s[24:27], s14 offen sc1 lds
    s_add_u32 m0, s5, 1024
    s_add_u32 s14, s12, 8192
    buffer_load_dwordx4 v3, s[24:27], s14 offen sc1 lds
    s_add_u32 m0, s5, 2048
    s_add_u32 s14, s12, 16384
    buffer_load_dwordx4 v3, s[24:27], s14 offen sc1 lds
    s_add_u32 m0, s5, 3072
    s_add_u32 s14, s12, 24576
    buffer_load_dwordx4 v3, s[24:27], s14 offen sc1 lds
    v_mov_b32 v16, 0
    v_mov_b32 v17, 0
    s_waitcnt vmcnt(0) lgkmcnt(0)
    ds_read_b64_tr_b16 v[64:65], v12 offset:0
    ds_read_b64_tr_b16 v[66:67], v12 offset:256
    ds_read_b64_tr_b16 v[68:69], v12 offset:1024
    ds_read_b64_tr_b16 v[70:71], v12 offset:1280
    ds_read_b64_tr_b16 v[72:73], v12 offset:2048
    ds_read_b64_tr_b16 v[74:75], v12 offset:2304
    ds_read_b64_tr_b16 v[76:77], v12 offset:3072
    ds_read_b64_tr_b16 v[78:79], v12 offset:3328
    s_waitcnt lgkmcnt(0)
    v_dot2_f32_bf16 v16, v64, v13, v16
    v_dot2_f32_bf16 v17, v64, v64, v17
    v_dot2_f32_bf16 v16, v65, v13, v16
    v_dot2_f32_bf16 v17, v65, v65, v17
    v_dot2_f32_bf16 v16, v66, v13, v16
    v_dot2_f32_bf16 v17, v66, v66, v17
    v_dot2_f32_bf16 v16, v67, v13, v16
    v_dot2_f32_bf16 v17, v67, v67, v17
    v_dot2_f32_bf16 v16, v68, v13, v16
    v_dot2_f32_bf16 v17, v68, v68, v17
    v_dot2_f32_bf16 v16, v69, v13, v16
    v_dot2_f32_bf16 v17, v69, v69, v17
    v_dot2_f32_bf16 v16, v70, v13, v16
    v_dot2_f32_bf16 v17, v70, v70, v17
    v_dot2_f32_bf16 v16, v71, v13, v16
    v_dot2_f32_bf16 v17, v71, v71, v17
    v_dot2_f32_bf16 v16, v72, v13, v16
    v_dot2_f32_bf16 v17, v72, v72, v17
    v_dot2_f32_bf16 v16, v73, v13, v16
    v_dot2_f32_bf16 v17, v73, v73, v17
    v_dot2_f32_bf16 v16, v74, v13, v16
    v_dot2_f32_bf16 v17, v74, v74, v17
    v_dot2_f32_bf16 v16, v75, v13, v16
    v_dot2_f32_bf16 v17, v75, v75, v17
    v_dot2_f32_bf16 v16, v76, v13, v16
    v_dot2_f32_bf16 v17, v76, v76, v17
    v_dot2_f32_bf16 v16, v77, v13, v16
    v_dot2_f32_bf16 v17, v77, v77, v17
    v_dot2_f32_bf16 v16, v78, v13, v16
    v_dot2_f32_bf16 v17, v78, v78, v17
    v_dot2_f32_bf16 v16, v79, v13, v16
    v_dot2_f32_bf16 v17, v79, v79, v17
    s_nop 2
    s_branch L_pv0
L_po0:
    s_add_u32 m0, s5, 4096
    s_add_u32 s14, s12, 32768
    buffer_load_dwordx4 v3, s[24:27], s14 offen sc1 lds
    s_add_u32 m0, s5, 5120
    s_add_u32 s14, s12, 40960
    buffer_load_dwordx4 v3, s[24:27], s14 offen sc1 lds
    s_add_u32 m0, s5, 6144
    s_add_u32 s14, s12, 49152
    buffer_load_dwordx4 v3, s[24:27], s14 offen sc1 lds
    s_add_u32 m0, s5, 7168
    s_add_u32 s14, s12, 57344
    buffer_load_dwordx4 v3, s[24:27], s14 offen sc1 lds
    s_add_u32 m0, s5, 8192
    s_add_u32 s14, s12, 65536
    buffer_load_dwordx4 v3, s[24:27], s14 offen sc1 lds
    s_add_u32 m0, s5, 9216
    s_add_u32 s14, s12, 73728
    buffer_load_dwordx4 v3, s[24:27], s14 offen sc1 lds
    s_add_u32 m0, s5, 10240
    s_add_u32 s14, s12, 81920
    buffer_load_dwordx4 v3, s[24:27], s14 offen sc1 lds
    s_add_u32 m0, s5, 11264
    s_add_u32 s14, s12, 90112
    buffer_load_dwordx4 v3, s[24:27], s14 offen sc1 lds
    s_add_u32 m0, s5, 12288
    s_add_u32 s14, s12, 98304
    buffer_load_dwordx4 v3, s[24:27], s14 offen sc1 lds
    s_add_u32 m0, s5, 13312
    s_add_u32 s14, s12, 106496
    buffer_load_dwordx4 v3, s[24:27], s14 offen sc1 lds
    s_add_u32 m0, s5, 14336
    s_add_u32 s14, s12, 114688
    buffer_load_dwordx4 v3, s[24:27], s14 offen sc1 lds
    s_add_u32 m0, s5, 15360
    s_add_u32 s14, s12, 122880
    buffer_load_dwordx4 v3, s[24:27], s14 offen sc1 lds
    s_add_u32 m0, s5, 0
    s_add_u32 s14, s12, 131072
    buffer_load_dwordx4 v3, s[24:27], s14 offen sc1 lds
    s_add_u32 m0, s5, 1024
    s_add_u32 s14, s12, 139264
    buffer_load_dwordx4 v3, s[24:27], s14 offen sc1 lds
    s_add_u32 m0, s5, 2048
    s_add_u32 s14, s12, 147456
    buffer_load_dwordx4 v3, s[24:27], s14 offen sc1 lds
    s_add_u32 m0, s5, 3072
    s_add_u32 s14, s12, 155648
    buffer_load_dwordx4 v3, s[24:27], s14 offen sc1 lds
    s_waitcnt vmcnt(15)
    ds_read_b64_tr_b16 v[48:49], v12 offset:4096
    ds_read_b64_tr_b16 v[50:51], v12 offset:4352
    s_waitcnt vmcnt(14)
    ds_read_b64_tr_b16 v[52:53], v12 offset:5120
    ds_read_b64_tr_b16 v[54:55], v12 offset:5376
    s_waitcnt vmcnt(13)
    ds_read_b64_tr_b16 v[56:57], v12 offset:6144
    ds_read_b64_tr_b16 v[58:59], v12 offset:6400
    s_waitcnt vmcnt(12)
    ds_read_b64_tr_b16 v[60:61], v12 offset:7168
    ds_read_b64_tr_b16 v[62:63], v12 offset:7424
    s_waitcnt lgkmcnt(6)
    v_dot2_f32_bf16 v18, v48, v13, v18
    v_dot2_f32_bf16 v19, v48, v48, v19
    v_dot2_f32_bf16 v18, v49, v13, v18
    v_dot2_f32_bf16 v19, v49, v49, v19
    v_dot2_f32_bf16 v18, v50, v13, v18
    v_dot2_f32_bf16 v19, v50, v50, v19
    v_dot2_f32_bf16 v18, v51, v13, v18
    v_dot2_f32_bf16 v19, v51, v51, v19
    s_waitcnt vmcnt(11)
    ds_read_b64_tr_b16 v[32:33], v12 offset:8192
    ds_read_b64_tr_b16 v[34:35], v12 offset:8448
    s_waitcnt lgkmcnt(6)
    v_dot2_f32_bf16 v18, v52, v13, v18
    v_dot2_f32_bf16 v19, v52, v52, v19
    v_dot2_f32_bf16 v18, v53, v13, v18
    v_dot2_f32_bf16 v19, v53, v53, v19
    v_dot2_f32_bf16 v18, v54, v13, v18
    v_dot2_f32_bf16 v19, v54, v54, v19
    v_dot2_f32_bf16 v18, v55, v13, v18
    v_dot2_f32_bf16 v19, v55, v55, v19
    s_waitcnt vmcnt(10)
    ds_read_b64_tr_b16 v[36:37], v12 offset:9216
    ds_read_b64_tr_b16 v[38:39], v12 offset:9472
    s_waitcnt lgkmcnt(6)
    v_dot2_f32_bf16 v18, v56, v13, v18
    v_dot2_f32_bf16 v19, v56, v56, v19
    v_dot2_f32_bf16 v18, v57, v13, v18
    v_dot2_f32_bf16 v19, v57, v57, v19
    v_dot2_f32_bf16 v18, v58, v13, v18
    v_dot2_f32_bf16 v19, v58, v58, v19
    v_dot2_f32_bf16 v18, v59, v13, v18
    v_dot2_f32_bf16 v19, v59, v59, v19
    s_waitcnt vmcnt(9)
    ds_read_b64_tr_b16 v[40:41], v12 offset:10240
    ds_read_b64_tr_b16 v[42:43], v12 offset:10496
    s_waitcnt lgkmcnt(6)
    v_dot2_f32_bf16 v18, v60, v13, v18
    v_dot2_f32_bf16 v19, v60, v60, v19
    v_dot2_f32_bf16 v18, v61, v13, v18
    v_dot2_f32_bf16 v19, v61, v61, v19
    v_dot2_f32_bf16 v18, v62, v13, v18
    v_dot2_f32_bf16 v19, v62, v62, v19
    v_dot2_f32_bf16 v18, v63, v13, v18
    v_dot2_f32_bf16 v19, v63, v63, v19
    s_nop 2
L_pv1:
    v_cmp_u_f32 vcc, v19, v19
    s_cmp_eq_u64 vcc, 0
    s_cbranch_scc1 L_po1
    s_add_u32 s13, s13, 1
    s_cmp_ge_u32 s13, 200000
    s_cbranch_scc1 L_po1
    s_sleep 3
    s_add_u32 m0, s5, 4096
    s_add_u32 s14, s12, 32768
    buffer_load_dwordx4 v3, s[24:27], s14 offen sc1 lds
    s_add_u32 m0, s5, 5120
    s_add_u32 s14, s12, 40960
    buffer_load_dwordx4 v3, s[24:27], s14 offen sc1 lds
    s_add_u32 m0, s5, 6144
    s_add_u32 s14, s12, 49152
    buffer_load_dwordx4 v3, s[24:27], s14 offen sc1 lds
    s_add_u32 m0, s5, 7168
    s_add_u32 s14, s12, 57344
    buffer_load_dwordx4 v3, s[24:27], s14 offen sc1 lds
    v_mov_b32 v18, 0
    v_mov_b32 v19, 0
    s_waitcnt vmcnt(0) lgkmcnt(0)
    ds_read_b64_tr_b16 v[64:65], v12 offset:4096
    ds_read_b64_tr_b16 v[66:67], v12 offset:4352
    ds_read_b64_tr_b16 v[68:69], v12 offset:5120
    ds_read_b64_tr_b16 v[70:71], v12 offset:5376
    ds_read_b64_tr_b16 v[72:73], v12 offset:6144
    ds_read_b64_tr_b16 v[74:75], v12 offset:6400
    ds_read_b64_tr_b16 v[76:77], v12 offset:7168
    ds_read_b64_tr_b16 v[78:79], v12 offset:7424
    s_waitcnt lgkmcnt(0)
    v_dot2_f32_bf16 v18, v64, v13, v18
    v_dot2_f32_bf16 v19, v64, v64, v19
    v_dot2_f32_bf16 v18, v65, v13, v18
    v_dot2_f32_bf16 v19, v65, v65, v19
    v_dot2_f32_bf16 v18, v66, v13, v18
    v_dot2_f32_bf16 v19, v66, v66, v19
    v_dot2_f32_bf16 v18, v67, v13, v18
    v_dot2_f32_bf16 v19, v67, v67, v19
    v_dot2_f32_bf16 v18, v68, v13, v18
    v_dot2_f32_bf16 v19, v68, v68, v19
    v_dot2_f32_bf16 v18, v69, v13, v18
    v_dot2_f32_bf16 v19, v69, v69, v19
    v_dot2_f32_bf16 v18, v70, v13, v18
    v_dot2_f32_bf16 v19, v70, v70, v19
    v_dot2_f32_bf16 v18, v71, v13, v18
    v_dot2_f32_bf16 v19, v71, v71, v19
    v_dot2_f32_bf16 v18, v72, v13, v18
    v_dot2_f32_bf16 v19, v72, v72, v19
    v_dot2_f32_bf16 v18, v73, v13, v18
    v_dot2_f32_bf16 v19, v73, v73, v19
    v_dot2_f32_bf16 v18, v74, v13, v18
    v_dot2_f32_bf16 v19, v74, v74, v19
    v_dot2_f32_bf16 v18, v75, v13, v18
    v_dot2_f32_bf16 v19, v75, v75, v19
    v_dot2_f32_bf16 v18, v76, v13, v18
    v_dot2_f32_bf16 v19, v76, v76, v19
    v_dot2_f32_bf16 v18, v77, v13, v18
    v_dot2_f32_bf16 v19, v77, v77, v19
    v_dot2_f32_bf16 v18, v78, v13, v18
    v_dot2_f32_bf16 v19, v78, v78, v19
    v_dot2_f32_bf16 v18, v79, v13, v18
    v_dot2_f32_bf16 v19, v79, v79, v19
    s_nop 2
    s_branch L_pv1
L_po1:
    s_waitcnt vmcnt(8)
    ds_read_b64_tr_b16 v[44:45], v12 offset:11264
    ds_read_b64_tr_b16 v[46:47], v12 offset:11520
    s_waitcnt lgkmcnt(6)
    v_dot2_f32_bf16 v20, v32, v13, v20
    v_dot2_f32_bf16 v21, v32, v32, v21
    v_dot2_f32_bf16 v20, v33, v13, v20
    v_dot2_f32_bf16 v21, v33, v33, v21
    v_dot2_f32_bf16 v20, v34, v13, v20
    v_dot2_f32_bf16 v21, v34, v34, v21
    v_dot2_f32_bf16 v20, v35, v13, v20
    v_dot2_f32_bf16 v21, v35, v35, v21
    s_waitcnt vmcnt(7)
    ds_read_b64_tr_b16 v[48:49], v12 offset:12288
    ds_read_b64_tr_b16 v[50:51], v12 offset:12544
    s_waitcnt lgkmcnt(6)
    v_dot2_f32_bf16 v20, v36, v13, v20
    v_dot2_f32_bf16 v21, v36, v36, v21
    v_dot2_f32_bf16 v20, v37, v13, v20
    v_dot2_f32_bf16 v21, v37, v37, v21
    v_dot2_f32_bf16 v20, v38, v13, v20
    v_dot2_f32_bf16 v21, v38, v38, v21
    v_dot2_f32_bf16 v20, v39, v13, v20
    v_dot2_f32_bf16 v21, v39, v39, v21
    s_waitcnt vmcnt(6)
    ds_read_b64_tr_b16 v[52:53], v12 offset:13312
    ds_read_b64_tr_b16 v[54:55], v12 offset:13568
    s_waitcnt lgkmcnt(6)
    v_dot2_f32_bf16 v20, v40, v13, v20
    v_dot2_f32_bf16 v21, v40, v40, v21
    v_dot2_f32_bf16 v20, v41, v13, v20
    v_dot2_f32_bf16 v21, v41, v41, v21
    v_dot2_f32_bf16 v20, v42, v13, v20
    v_dot2_f32_bf16 v21, v42, v42, v21
    v_dot2_f32_bf16 v20, v43, v13, v20
    v_dot2_f32_bf16 v21, v43, v43, v21
    s_waitcnt vmcnt(5)
    ds_read_b64_tr_b16 v[56:57], v12 offset:14336
    ds_read_b64_tr_b16 v[58:59], v12 offset:14592
    s_waitcnt lgkmcnt(6)
    v_dot2_f32_bf16 v20, v44, v13, v20
    v_dot2_f32_bf16 v21, v44, v44, v21
    v_dot2_f32_bf16 v20, v45, v13, v20
    v_dot2_f32_bf16 v21, v45, v45, v21
    v_dot2_f32_bf16 v20, v46, v13, v20
    v_dot2_f32_bf16 v21, v46, v46, v21
    v_dot2_f32_bf16 v20, v47, v13, v20
    v_dot2_f32_bf16 v21, v47, v47, v21
    s_nop 2
L_pv2:
    v_cmp_u_f32 vcc, v21, v21
    s_cmp_eq_u64 vcc, 0
    s_cbranch_scc1 L_po2
    s_add_u32 s13, s13, 1
    s_cmp_ge_u32 s13, 200000
    s_cbranch_scc1 L_po2
    s_sleep 3
    s_add_u32 m0, s5, 8192
    s_add_u32 s14, s12, 65536
    buffer_load_dwordx4 v3, s[24:27], s14 offen sc1 lds
    s_add_u32 m0, s5, 9216
    s_add_u32 s14, s12, 73728
    buffer_load_dwordx4 v3, s[24:27], s14 offen sc1 lds
    s_add_u32 m0, s5, 10240
    s_add_u32 s14, s12, 81920
    buffer_load_dwordx4 v3, s[24:27], s14 offen sc1 lds
    s_add_u32 m0, s5, 11264
    s_add_u32 s14, s12, 90112
    buffer_load_dwordx4 v3, s[24:27], s14 offen sc1 lds
    v_mov_b32 v20, 0
    v_mov_b32 v21, 0
    s_waitcnt vmcnt(0) lgkmcnt(0)
    ds_read_b64_tr_b16 v[64:65], v12 offset:8192
    ds_read_b64_tr_b16 v[66:67], v12 offset:8448
    ds_read_b64_tr_b16 v[68:69], v12 offset:9216
    ds_read_b64_tr_b16 v[70:71], v12 offset:9472
    ds_read_b64_tr_b16 v[72:73], v12 offset:10240
    ds_read_b64_tr_b16 v[74:75], v12 offset:10496
    ds_read_b64_tr_b16 v[76:77], v12 offset:11264
    ds_read_b64_tr_b16 v[78:79], v12 offset:11520
    s_waitcnt lgkmcnt(0)
    v_dot2_f32_bf16 v20, v64, v13, v20
    v_dot2_f32_bf16 v21, v64, v64, v21
    v_dot2_f32_bf16 v20, v65, v13, v20
    v_dot2_f32_bf16 v21, v65, v65, v21
    v_dot2_f32_bf16 v20, v66, v13, v20
    v_dot2_f32_bf16 v21, v66, v66, v21
    v_dot2_f32_bf16 v20, v67, v13, v20
    v_dot2_f32_bf16 v21, v67, v67, v21
    v_dot2_f32_bf16 v20, v68, v13, v20
    v_dot2_f32_bf16 v21, v68, v68, v21
    v_dot2_f32_bf16 v20, v69, v13, v20
    v_dot2_f32_bf16 v21, v69, v69, v21
    v_dot2_f32_bf16 v20, v70, v13, v20
    v_dot2_f32_bf16 v21, v70, v70, v21
    v_dot2_f32_bf16 v20, v71, v13, v20
    v_dot2_f32_bf16 v21, v71, v71, v21
    v_dot2_f32_bf16 v20, v72, v13, v20
    v_dot2_f32_bf16 v21, v72, v72, v21
    v_dot2_f32_bf16 v20, v73, v13, v20
    v_dot2_f32_bf16 v21, v73, v73, v21
    v_dot2_f32_bf16 v20, v74, v13, v20
    v_dot2_f32_bf16 v21, v74, v74, v21
    v_dot2_f32_bf16 v20, v75, v13, v20
    v_dot2_f32_bf16 v21, v75, v75, v21
    v_dot2_f32_bf16 v20, v76, v13, v20
    v_dot2_f32_bf16 v21, v76, v76, v21
    v_dot2_f32_bf16 v20, v77, v13, v20
    v_dot2_f32_bf16 v21, v77, v77, v21
    v_dot2_f32_bf16 v20, v78, v13, v20
    v_dot2_f32_bf16 v21, v78, v78, v21
    v_dot2_f32_bf16 v20, v79, v13, v20
    v_dot2_f32_bf16 v21, v79, v79, v21
    s_nop 2
    s_branch L_pv2
L_po2:
    s_waitcnt vmcnt(4)
    ds_read_b64_tr_b16 v[60:61], v12 offset:15360
    ds_read_b64_tr_b16 v[62:63], v12 offset:15616
    s_waitcnt lgkmcnt(6)
    v_dot2_f32_bf16 v22, v48, v13, v22
    v_dot2_f32_bf16 v23, v48, v48, v23
    v_dot2_f32_bf16 v22, v49, v13, v22
    v_dot2_f32_bf16 v23, v49, v49, v23
    v_dot2_f32_bf16 v22, v50, v13, v22
    v_dot2_f32_bf16 v23, v50, v50, v23
    v_dot2_f32_bf16 v22, v51, v13, v22
    v_dot2_f32_bf16 v23, v51, v51, v23
    s_waitcnt vmcnt(3)
    ds_read_b64_tr_b16 v[32:33], v12 offset:0
    ds_read_b64_tr_b16 v[34:35], v12 offset:256
    s_waitcnt lgkmcnt(6)
    v_dot2_f32_bf16 v22, v52, v13, v22
    v_dot2_f32_bf16 v23, v52, v52, v23
    v_dot2_f32_bf16 v22, v53, v13, v22
    v_dot2_f32_bf16 v23, v53, v53, v23
    v_dot2_f32_bf16 v22, v54, v13, v22
    v_dot2_f32_bf16 v23, v54, v54, v23
    v_dot2_f32_bf16 v22, v55, v13, v22
    v_dot2_f32_bf16 v23, v55, v55, v23
    s_waitcnt vmcnt(2)
    ds_read_b64_tr_b16 v[36:37], v12 offset:1024
    ds_read_b64_tr_b16 v[38:39], v12 offset:1280
    s_waitcnt lgkmcnt(6)
    v_dot2_f32_bf16 v22, v56, v13, v22
    v_dot2_f32_bf16 v23, v56, v56, v23
    v_dot2_f32_bf16 v22, v57, v13, v22
    v_dot2_f32_bf16 v23, v57, v57, v23
    v_dot2_f32_bf16 v22, v58, v13, v22
    v_dot2_f32_bf16 v23, v58, v58, v23
    v_dot2_f32_bf16 v22, v59, v13, v22
    v_dot2_f32_bf16 v23, v59, v59, v23
    s_waitcnt vmcnt(1)
    ds_read_b64_tr_b16 v[40:41], v12 offset:2048
    ds_read_b64_tr_b16 v[42:43], v12 offset:2304
    s_waitcnt lgkmcnt(6)
    v_dot2_f32_bf16 v22, v60, v13, v22
    v_dot2_f32_bf16 v23, v60, v60, v23
    v_dot2_f32_bf16 v22, v61, v13, v22
    v_dot2_f32_bf16 v23, v61, v61, v23
    v_dot2_f32_bf16 v22, v62, v13, v22
    v_dot2_f32_bf16 v23, v62, v62, v23
    v_dot2_f32_bf16 v22, v63, v13, v22
    v_dot2_f32_bf16 v23, v63, v63, v23
    s_nop 2
L_pv3:
    v_cmp_u_f32 vcc, v23, v23
    s_cmp_eq_u64 vcc, 0
    s_cbranch_scc1 L_po3
    s_add_u32 s13, s13, 1
    s_cmp_ge_u32 s13, 200000
    s_cbranch_scc1 L_po3
    s_sleep 3
    s_add_u32 m0, s5, 12288
    s_add_u32 s14, s12, 98304
    buffer_load_dwordx4 v3, s[24:27], s14 offen sc1 lds
    s_add_u32 m0, s5, 13312
    s_add_u32 s14, s12, 106496
    buffer_load_dwordx4 v3, s[24:27], s14 offen sc1 lds
    s_add_u32 m0, s5, 14336
    s_add_u32 s14, s12, 114688
    buffer_load_dwordx4 v3, s[24:27], s14 offen sc1 lds
    s_add_u32 m0, s5, 15360
    s_add_u32 s14, s12, 122880
    buffer_load_dwordx4 v3, s[24:27], s14 offen sc1 lds
    v_mov_b32 v22, 0
    v_mov_b32 v23, 0
    s_waitcnt vmcnt(0) lgkmcnt(0)
    ds_read_b64_tr_b16 v[64:65], v12 offset:12288
    ds_read_b64_tr_b16 v[66:67], v12 offset:12544
    ds_read_b64_tr_b16 v[68:69], v12 offset:13312
    ds_read_b64_tr_b16 v[70:71], v12 offset:13568
    ds_read_b64_tr_b16 v[72:73], v12 offset:14336
    ds_read_b64_tr_b16 v[74:75], v12 offset:14592
    ds_read_b64_tr_b16 v[76:77], v12 offset:15360
    ds_read_b64_tr_b16 v[78:79], v12 offset:15616
    s_waitcnt lgkmcnt(0)
    v_dot2_f32_bf16 v22, v64, v13, v22
    v_dot2_f32_bf16 v23, v64, v64, v23
    v_dot2_f32_bf16 v22, v65, v13, v22
    v_dot2_f32_bf16 v23, v65, v65, v23
    v_dot2_f32_bf16 v22, v66, v13, v22
    v_dot2_f32_bf16 v23, v66, v66, v23
    v_dot2_f32_bf16 v22, v67, v13, v22
    v_dot2_f32_bf16 v23, v67, v67, v23
    v_dot2_f32_bf16 v22, v68, v13, v22
    v_dot2_f32_bf16 v23, v68, v68, v23
    v_dot2_f32_bf16 v22, v69, v13, v22
    v_dot2_f32_bf16 v23, v69, v69, v23
    v_dot2_f32_bf16 v22, v70, v13, v22
    v_dot2_f32_bf16 v23, v70, v70, v23
    v_dot2_f32_bf16 v22, v71, v13, v22
    v_dot2_f32_bf16 v23, v71, v71, v23
    v_dot2_f32_bf16 v22, v72, v13, v22
    v_dot2_f32_bf16 v23, v72, v72, v23
    v_dot2_f32_bf16 v22, v73, v13, v22
    v_dot2_f32_bf16 v23, v73, v73, v23
    v_dot2_f32_bf16 v22, v74, v13, v22
    v_dot2_f32_bf16 v23, v74, v74, v23
    v_dot2_f32_bf16 v22, v75, v13, v22
    v_dot2_f32_bf16 v23, v75, v75, v23
    v_dot2_f32_bf16 v22, v76, v13, v22
    v_dot2_f32_bf16 v23, v76, v76, v23
    v_dot2_f32_bf16 v22, v77, v13, v22
    v_dot2_f32_bf16 v23, v77, v77, v23
    v_dot2_f32_bf16 v22, v78, v13, v22
    v_dot2_f32_bf16 v23, v78, v78, v23
    v_dot2_f32_bf16 v22, v79, v13, v22
    v_dot2_f32_bf16 v23, v79, v79, v23
    s_nop 2
    s_branch L_pv3
L_po3:
    s_waitcnt vmcnt(0)
    ds_read_b64_tr_b16 v[44:45], v12 offset:3072
    ds_read_b64_tr_b16 v[46:47], v12 offset:3328
    s_waitcnt lgkmcnt(6)
    v_dot2_f32_bf16 v24, v32, v13, v24
    v_dot2_f32_bf16 v25, v32, v32, v25
    v_dot2_f32_bf16 v24, v33, v13, v24
    v_dot2_f32_bf16 v25, v33, v33, v25
    v_dot2_f32_bf16 v24, v34, v13, v24
    v_dot2_f32_bf16 v25, v34, v34, v25
    v_dot2_f32_bf16 v24, v35, v13, v24
    v_dot2_f32_bf16 v25, v35, v35, v25
    s_waitcnt lgkmcnt(4)
    v_dot2_f32_bf16 v24, v36, v13, v24
    v_dot2_f32_bf16 v25, v36, v36, v25
    v_dot2_f32_bf16 v24, v37, v13, v24
    v_dot2_f32_bf16 v25, v37, v37, v25
    v_dot2_f32_bf16 v24, v38, v13, v24
    v_dot2_f32_bf16 v25, v38, v38, v25
    v_dot2_f32_bf16 v24, v39, v13, v24
    v_dot2_f32_bf16 v25, v39, v39, v25
    s_waitcnt lgkmcnt(2)
    v_dot2_f32_bf16 v24, v40, v13, v24
    v_dot2_f32_bf16 v25, v40, v40, v25
    v_dot2_f32_bf16 v24, v41, v13, v24
    v_dot2_f32_bf16 v25, v41, v41, v25
    v_dot2_f32_bf16 v24, v42, v13, v24
    v_dot2_f32_bf16 v25, v42, v42, v25
    v_dot2_f32_bf16 v24, v43, v13, v24
    v_dot2_f32_bf16 v25, v43, v43, v25
    s_waitcnt lgkmcnt(0)
    v_dot2_f32_bf16 v24, v44, v13, v24
    v_dot2_f32_bf16 v25, v44, v44, v25
    v_dot2_f32_bf16 v24, v45, v13, v24
    v_dot2_f32_bf16 v25, v45, v45, v25
    v_dot2_f32_bf16 v24, v46, v13, v24
    v_dot2_f32_bf16 v25, v46, v46, v25
    v_dot2_f32_bf16 v24, v47, v13, v24
    v_dot2_f32_bf16 v25, v47, v47, v25
    s_nop 2
L_pv4:
    v_cmp_u_f32 vcc, v25, v25
    s_cmp_eq_u64 vcc, 0
    s_cbranch_scc1 L_po4
    s_add_u32 s13, s13, 1
    s_cmp_ge_u32 s13, 200000
    s_cbranch_scc1 L_po4
    s_sleep 3
    s_add_u32 m0, s5, 0
    s_add_u32 s14, s12, 131072
    buffer_load_dwordx4 v3, s[24:27], s14 offen sc1 lds
    s_add_u32 m0, s5, 1024
    s_add_u32 s14, s12, 139264
    buffer_load_dwordx4 v3, s[24:27], s14 offen sc1 lds
    s_add_u32 m0, s5, 2048
    s_add_u32 s14, s12, 147456
    buffer_load_dwordx4 v3, s[24:27], s14 offen sc1 lds
    s_add_u32 m0, s5, 3072
    s_add_u32 s14, s12, 155648
    buffer_load_dwordx4 v3, s[24:27], s14 offen sc1 lds
    v_mov_b32 v24, 0
    v_mov_b32 v25, 0
    s_waitcnt vmcnt(0) lgkmcnt(0)
    ds_read_b64_tr_b16 v[64:65], v12 offset:0
    ds_read_b64_tr_b16 v[66:67], v12 offset:256
    ds_read_b64_tr_b16 v[68:69], v12 offset:1024
    ds_read_b64_tr_b16 v[70:71], v12 offset:1280
    ds_read_b64_tr_b16 v[72:73], v12 offset:2048
    ds_read_b64_tr_b16 v[74:75], v12 offset:2304
    ds_read_b64_tr_b16 v[76:77], v12 offset:3072
    ds_read_b64_tr_b16 v[78:79], v12 offset:3328
    s_waitcnt lgkmcnt(0)
    v_dot2_f32_bf16 v24, v64, v13, v24
    v_dot2_f32_bf16 v25, v64, v64, v25
    v_dot2_f32_bf16 v24, v65, v13, v24
    v_dot2_f32_bf16 v25, v65, v65, v25
    v_dot2_f32_bf16 v24, v66, v13, v24
    v_dot2_f32_bf16 v25, v66, v66, v25
    v_dot2_f32_bf16 v24, v67, v13, v24
    v_dot2_f32_bf16 v25, v67, v67, v25
    v_dot2_f32_bf16 v24, v68, v13, v24
    v_dot2_f32_bf16 v25, v68, v68, v25
    v_dot2_f32_bf16 v24, v69, v13, v24
    v_dot2_f32_bf16 v25, v69, v69, v25
    v_dot2_f32_bf16 v24, v70, v13, v24
    v_dot2_f32_bf16 v25, v70, v70, v25
    v_dot2_f32_bf16 v24, v71, v13, v24
    v_dot2_f32_bf16 v25, v71, v71, v25
    v_dot2_f32_bf16 v24, v72, v13, v24
    v_dot2_f32_bf16 v25, v72, v72, v25
    v_dot2_f32_bf16 v24, v73, v13, v24
    v_dot2_f32_bf16 v25, v73, v73, v25
    v_dot2_f32_bf16 v24, v74, v13, v24
    v_dot2_f32_bf16 v25, v74, v74, v25
    v_dot2_f32_bf16 v24, v75, v13, v24
    v_dot2_f32_bf16 v25, v75, v75, v25
    v_dot2_f32_bf16 v24, v76, v13, v24
    v_dot2_f32_bf16 v25, v76, v76, v25
    v_dot2_f32_bf16 v24, v77, v13, v24
    v_dot2_f32_bf16 v25, v77, v77, v25
    v_dot2_f32_bf16 v24, v78, v13, v24
    v_dot2_f32_bf16 v25, v78, v78, v25
    v_dot2_f32_bf16 v24, v79, v13, v24
    v_dot2_f32_bf16 v25, v79, v79, v25
    s_nop 2
    s_branch L_pv4
L_po4:
    s_nop 2
    v_permlane32_swap_b32 v16, v17
    v_permlane32_swap_b32 v18, v19
    v_permlane32_swap_b32 v20, v21
    v_permlane32_swap_b32 v22, v23
    v_permlane32_swap_b32 v24, v25
    v_add_f32 v16, v16, v17
    v_add_f32 v18, v18, v19
    v_add_f32 v20, v20, v21
    v_add_f32 v22, v22, v23
    v_add_f32 v24, v24, v25
    v_and_b32 v8, 31, v1
    v_lshlrev_b32 v8, 3, v8
    v_lshl_add_u32 v8, v7, 2, v8
    v_add_u32 v8, s5, v8
    ds_write_b32 v8, v16 offset:0
    ds_write_b32 v8, v18 offset:256
    ds_write_b32 v8, v20 offset:512
    ds_write_b32 v8, v22 offset:768
    ds_write_b32 v8, v24 offset:1024
    s_waitcnt lgkmcnt(0)
    s_barrier
    s_cmp_ge_u32 s3, 3
    s_cbranch_scc1 L_m_pe
    v_lshlrev_b32 v8, 3, v0
    v_add_u32 v9, 0x10000, v8
    ds_read_b64 v[32:33], v8 offset:0
    ds_read_b64 v[34:35], v8 offset:16384
    ds_read_b64 v[36:37], v8 offset:32768
    ds_read_b64 v[38:39], v8 offset:49152
    ds_read_b64 v[40:41], v9 offset:0
    ds_read_b64 v[42:43], v9 offset:16384
    ds_read_b64 v[44:45], v9 offset:32768
    ds_read_b64 v[46:47], v9 offset:49152
    s_waitcnt lgkmcnt(0)
    v_pk_add_f32 v[32:33], v[32:33], v[34:35]
    v_pk_add_f32 v[36:37], v[36:37], v[38:39]
    v_pk_add_f32 v[40:41], v[40:41], v[42:43]
    v_pk_add_f32 v[44:45], v[44:45], v[46:47]
    v_pk_add_f32 v[32:33], v[32:33], v[36:37]
    v_pk_add_f32 v[40:41], v[40:41], v[44:45]
    v_pk_add_f32 v[32:33], v[32:33], v[40:41]
    s_mov_b32 s24, 0x3b000000
    s_mov_b32 s25, 0x3727c5ac
    v_mul_f32 v14, s24, v32
    v_mul_f32 v16, s24, v33
    v_fma_f32 v16, -v14, v14, v16
    v_max_f32 v16, 0, v16
    v_cvt_pk_bf16_f32 v14, v14, v16
    v_and_b32 v16, 0xffff0000, v14
    v_lshlrev_b32 v14, 16, v14
    v_add_f32 v16, s25, v16
    v_cvt_pk_bf16_f32 v16, v16, v16
    v_lshlrev_b32 v16, 16, v16
    v_sqrt_f32 v16, v16
    s_mul_i32 s4, s2, 1280
    s_add_u32 s4, s4, s89
    v_cvt_pk_bf16_f32 v20, v14, v16
    v_mov_b32 v21, 1
    s_movk_i32 s6, 160
    v_cmp_gt_u32 vcc, s6, v0
    s_and_saveexec_b64 s[6:7], vcc
    buffer_store_dwordx2 v[20:21], v8, s[8:11], s4 offen sc1
    s_mov_b64 exec, s[6:7]
    s_nop 1
    L_m_pe:
    s_branch L_m_dall
L_mega_end:
    s_endpgm
.section .rodata,"a"
.p2align 6
.amdhsa_kernel interleave_layers__ssm_conv_s4d__glu_gated_glu__prompt_kernel
  .amdhsa_next_free_vgpr 256
  .amdhsa_next_free_sgpr 100
  .amdhsa_accum_offset 256
  .amdhsa_group_segment_fixed_size 0
  .amdhsa_kernarg_size 112
  .amdhsa_user_sgpr_count 2
  .amdhsa_user_sgpr_kernarg_segment_ptr 1
  .amdhsa_system_sgpr_workgroup_id_x 1
.end_amdhsa_kernel
```
